```python
import torch

def _softmax(x, axis=-1):
    return torch.softmax(x, dim=axis)
def _gelu(x):
    return torch.nn.functional.gelu(x, approximate="tanh")
def _silu(x):
    return torch.nn.functional.silu(x)
def _sigmoid(x):
    return torch.sigmoid(x)
def _layernorm(x, axis=-1, eps=1e-5):
    m = x.mean(dim=axis, keepdim=True)
    v = x.var(dim=axis, keepdim=True, unbiased=False)
    return (x - m) / torch.sqrt(v + eps)
def _scatter_add(tgt, idx, src, axis=0):
    return tgt.clone().index_add_(axis, idx, src)
def _segment_sum(src, seg, n):
    out = torch.zeros((n,) + src.shape[1:], dtype=src.dtype)
    return out.index_add_(0, seg, src)
def _pad(x, pw):
    flat = tuple(v for pair in reversed(pw) for v in pair)
    return torch.nn.functional.pad(x, flat)

kernel_name = 'gated_mix__ssm_conv_s5__dense_activation_squared_relu__prompt'

def setup_inputs():

    _w = (lambda a: (lambda t: t.to(torch.bfloat16) if t.is_floating_point() else t)(torch.as_tensor(a)))
    def _A_setup():
        B, S, D = 1, 2048, 640
        P = D
        Lambda_re = -0.5 * (lambda _x: torch.exp(torch.as_tensor(_x)))((lambda *s: torch.randn(*s, dtype=torch.bfloat16) * 0.4)(P))
        Lambda_im = (lambda *s: torch.randn(*s, dtype=torch.bfloat16) * 0.8)(P) * 1.0
        B_re = (lambda *s: torch.randn(*s, dtype=torch.bfloat16) * 0.8)(P, D) * (D ** -0.5)
        B_im = (lambda *s: torch.randn(*s, dtype=torch.bfloat16) * 0.8)(P, D) * (D ** -0.5)
        C_re = (lambda *s: torch.randn(*s, dtype=torch.bfloat16) * 0.4)(D, P) * (P ** -0.5)
        C_im = (lambda *s: torch.randn(*s, dtype=torch.bfloat16) * 0.8)(D, P) * (P ** -0.5)
        log_dt = (lambda *s: torch.randn(*s, dtype=torch.bfloat16) * 0.4)(P) * 0.3 - 2.0
        Dskip = (lambda *s: torch.randn(*s, dtype=torch.bfloat16) * 0.2)(D)
        return {
            "x": _w((lambda *s: torch.randn(*s, dtype=torch.bfloat16) * 0.05)(B, S, D)),
            "Lambda_re": _w(Lambda_re),
            "Lambda_im": _w(Lambda_im),
            "B_re": _w(B_re),
            "B_im": _w(B_im),
            "C_re": _w(C_re),
            "C_im": _w(C_im),
            "log_dt": _w(log_dt),
            "Dskip": _w(Dskip),
        }
    _A_in = _A_setup()

    def _B_setup():
        B, S, D, F = 1, 2048, 640, 1536
        return {
            "x": _w((lambda *s: torch.randn(*s, dtype=torch.bfloat16) * 0.05)(B, S, D)),
            "w1": _w((lambda *s: torch.randn(*s, dtype=torch.bfloat16) * 0.05)(D, F)),
            "b1": _w((lambda *s: torch.randn(*s, dtype=torch.bfloat16) * 0.05)(F)),
            "w2": _w((lambda *s: torch.randn(*s, dtype=torch.bfloat16) * 0.05)(F, D)),
            "b2": _w((lambda *s: torch.randn(*s, dtype=torch.bfloat16) * 0.05)(D)),
        }
    _B_in = _B_setup()

    return {
        "A_x": _A_in["x"],
        "A_Lambda_re": _A_in["Lambda_re"],
        "A_Lambda_im": _A_in["Lambda_im"],
        "A_B_re": _A_in["B_re"],
        "A_B_im": _A_in["B_im"],
        "A_C_re": _A_in["C_re"],
        "A_C_im": _A_in["C_im"],
        "A_log_dt": _A_in["log_dt"],
        "A_Dskip": _A_in["Dskip"],
        "B_x": _B_in["x"],
        "B_w1": _B_in["w1"],
        "B_b1": _B_in["b1"],
        "B_w2": _B_in["w2"],
        "B_b2": _B_in["b2"],
        "gate_w": _w((lambda *s: torch.randn(*s, dtype=torch.bfloat16) * 0.05)(640) * 16.0),
    }

def reference(A_x, A_Lambda_re, A_Lambda_im, A_B_re, A_B_im, A_C_re, A_C_im, A_log_dt, A_Dskip, B_x, B_w1, B_b1, B_w2, B_b2, gate_w):
    def _A_ref(x, Lambda_re, Lambda_im, B_re, B_im, C_re, C_im, log_dt, Dskip):
        Bsz, L, H = x.shape
        Lam = Lambda_re + 1j * Lambda_im
        Bmat = B_re + 1j * B_im
        Cmat = C_re + 1j * C_im
        dt = torch.exp(log_dt)
        Lam_bar = torch.exp(dt * Lam)
        B_bar = ((Lam_bar - 1.0) / Lam)[:, None] * Bmat
        Bu = torch.einsum("bld,pd->blp", x + 0j, B_bar)
        h = torch.zeros_like(Bu[:, 0, :])
        hs = []
        for t in range(L):
            h = Lam_bar[None, :] * h + Bu[:, t, :]
            hs.append(h)
        hseq = torch.stack(hs, 1)
        y = 2.0 * torch.einsum("blp,dp->bld", hseq, Cmat).real + x * Dskip[None, None, :]
        return y

    def _B_ref(x, w1, b1, w2, b2):
        h = torch.einsum("bsd,df->bsf", x, w1) + b1
        zero = torch.zeros_like(h)
        r = torch.where(h > zero, h, zero)
        h = r * r
        out = torch.einsum("bsf,fd->bsd", h, w2) + b2
        return out

    x = A_x
    g = _sigmoid((x * gate_w).sum(-1, keepdims=True))
    a = _A_ref(x, A_Lambda_re, A_Lambda_im, A_B_re, A_B_im, A_C_re, A_C_im, A_log_dt, A_Dskip)
    b = _B_ref(x, B_w1, B_b1, B_w2, B_b2)
    return g * a + (1 - g) * b
```

```asm
; @launch grid=(256,1,1) block=(512,1,1) lds=157504
.amdgcn_target "amdgcn-amd-amdhsa--gfx950"
.text
.globl gated_mix__ssm_conv_s5__dense_activation_squared_relu__prompt_kernel
.p2align 8
.type gated_mix__ssm_conv_s5__dense_activation_squared_relu__prompt_kernel,@function
gated_mix__ssm_conv_s5__dense_activation_squared_relu__prompt_kernel:
    s_cmp_ge_u32 s2, 256
    s_cbranch_scc1 L_end
    s_load_dwordx16 s[4:19], s[0:1], 0
    s_load_dwordx16 s[20:35], s[0:1], 64
    s_load_dwordx4 s[36:39], s[0:1], 128
    v_lshrrev_b32 v3, 6, v0
    v_and_b32 v1, 63, v0
    v_readfirstlane_b32 s48, v3
    v_lshlrev_b32 v2, 4, v1
    s_lshr_b32 s51, s2, 3
    s_bfe_u32 s44, s2, 0x10002
    s_lshr_b32 s52, s2, 5
    s_lshl3_add_u32 s44, s44, s52
    s_and_b32 s45, s2, 3
    s_and_b32 s52, s51, 3
    s_lshl2_add_u32 s45, s45, s52
    s_lshr_b32 s46, s45, 2
    s_and_b32 s47, s45, 3
    s_cmp_ge_u32 s48, 4
    s_cbranch_scc1 L_S
    v_lshrrev_b32 v36, 3, v1
    v_mul_u32_u24 v36, 1280, v36
    v_lshrrev_b32 v37, 4, v1
    v_and_b32 v38, 7, v1
    v_xor_b32 v37, v37, v38
    v_lshl_add_u32 v4, v37, 4, v36
    v_xor_b32 v5, 64, v4
    v_add_u32 v5, 9216, v5
    v_xor_b32 v6, 32, v4
    v_add_u32 v6, 18432, v6
    v_xor_b32 v7, 96, v4
    v_add_u32 v7, 27648, v7
    s_lshl2_add_u32 s50, s44, s48
    s_mul_i32 s68, s50, 40960
    v_mul_u32_u24 v37, 43691, v1
    v_lshrrev_b32 v37, 19, v37
    v_lshlrev_b32 v38, 2, v37
    v_and_b32 v38, 32, v38
    v_xor_b32 v38, v38, v2
    v_mul_u32_u24 v37, 2880, v37
    v_add_u32 v8, v37, v38
    v_add_u32 v36, 64, v1
    v_mul_u32_u24 v37, 43691, v36
    v_lshrrev_b32 v37, 19, v37
    v_lshlrev_b32 v38, 2, v37
    v_and_b32 v38, 32, v38
    v_xor_b32 v38, v38, v2
    v_mul_u32_u24 v37, 2880, v37
    v_add_u32 v9, v37, v38
    v_add_u32 v36, 128, v1
    v_mul_u32_u24 v37, 43691, v36
    v_lshrrev_b32 v37, 19, v37
    v_lshlrev_b32 v38, 2, v37
    v_and_b32 v38, 32, v38
    v_xor_b32 v38, v38, v2
    v_mul_u32_u24 v37, 2880, v37
    v_add_u32 v10, v37, v38
    s_mul_i32 s69, s45, 192
    s_mul_i32 s51, s48, 49152
    s_add_u32 s69, s69, s51
    s_waitcnt lgkmcnt(0)
    s_lshl_b32 s6, s48, 12
    s_mul_i32 s7, s48, 3072
    s_mov_b32 s60, s24
    s_mov_b32 s61, s25
    s_mov_b32 s62, 0x1e0000
    s_mov_b32 s63, 0x20000
    s_mov_b32 s56, s4
    s_mov_b32 s57, s5
    s_mov_b32 s58, 0x280000
    s_mov_b32 s59, 0x20000
    s_add_u32 m0, s7, 57472
    s_nop 0
    buffer_load_dwordx4 v8, s[60:63], s69 offen offset:0 lds
    buffer_load_dwordx4 v9, s[60:63], s69 offen offset:1024 lds
    buffer_load_dwordx4 v10, s[60:63], s69 offen offset:2048 lds
    s_add_u32 s69, s69, 196608
    s_add_u32 m0, s6, 30720
    s_nop 0
    buffer_load_dwordx4 v4, s[56:59], s68 offen offset:0 lds
    buffer_load_dwordx4 v5, s[56:59], s68 offen offset:1024 lds
    buffer_load_dwordx4 v6, s[56:59], s68 offen offset:2048 lds
    buffer_load_dwordx4 v7, s[56:59], s68 offen offset:3072 lds
    s_add_u32 s68, s68, 128
    s_lshr_b32 s14, s46, 1
    s_xor_b32 s14, s14, 1
    s_andn2_b32 s15, 1, s46
    v_and_b32 v36, 15, v1
    v_bfe_u32 v37, v1, 1, 3
    v_lshrrev_b32 v38, 4, v1
    v_xor_b32 v37, v37, v38
    v_lshlrev_b32 v37, 4, v37
    v_lshl_add_u32 v36, v36, 7, v37
    s_mul_i32 s51, s14, 2080
    v_xor_b32 v36, s51, v36
    s_lshl_b32 s50, s48, 12
    s_add_u32 s50, s50, 30720
    v_xor_b32 v15, 2080, v36
    v_xor_b32 v16, 64, v36
    v_xor_b32 v17, 2144, v36
    v_add_u32 v14, s50, v36
    v_add_u32 v15, s50, v15
    v_add_u32 v16, s50, v16
    v_add_u32 v17, s50, v17
    v_add_u32 v18, 78080, v14
    v_add_u32 v19, 78080, v15
    v_add_u32 v20, 78080, v16
    v_add_u32 v21, 78080, v17
    v_lshlrev_b32 v36, 4, v38
    v_add_u32 v26, 57344, v36
    v_add_u32 v27, 135424, v36
    v_bfe_u32 v36, v1, 2, 2
    v_lshl_add_u32 v36, v38, 3, v36
    v_mul_u32_u24 v36, 192, v36
    v_and_b32 v37, 3, v1
    v_lshl_add_u32 v36, v37, 3, v36
    v_and_b32 v37, 16, v1
    v_lshlrev_b32 v37, 1, v37
    v_add_u32 v36, 57472, v36
    v_add_u32 v22, v36, v37
    v_sub_u32 v23, v36, v37
    v_add_u32 v24, 78080, v22
    v_add_u32 v25, 78080, v23
    s_mov_b32 s40, s38
    s_mov_b32 s41, s39
    s_mov_b32 s42, 0x10000000
    s_mov_b32 s43, 0x20000
    buffer_load_dword v3, off, s[40:43], 0 sc1
    v_and_b32 v36, 15, v1
    s_mul_i32 s50, s45, 192
    v_lshl_add_u32 v36, v36, 1, s50
    global_load_ushort v200, v36, s[26:27] offset:0
    global_load_ushort v204, v36, s[26:27] offset:32
    global_load_ushort v208, v36, s[26:27] offset:64
    global_load_ushort v212, v36, s[26:27] offset:96
    global_load_ushort v216, v36, s[26:27] offset:128
    global_load_ushort v220, v36, s[26:27] offset:160
    v_mov_b32 v201, 0
    v_mov_b64 v[202:203], 0
    v_mov_b32 v205, 0
    v_mov_b64 v[206:207], 0
    v_mov_b32 v209, 0
    v_mov_b64 v[210:211], 0
    v_mov_b32 v213, 0
    v_mov_b64 v[214:215], 0
    v_mov_b32 v217, 0
    v_mov_b64 v[218:219], 0
    v_mov_b32 v221, 0
    v_mov_b64 v[222:223], 0
    v_mov_b32 v224, 0x3f80
    v_mov_b32 v225, 0
    v_mov_b64 v[226:227], 0
    v_add_u32 v36, 0, v1
    v_mul_u32_u24 v37, 3277, v36
    v_lshrrev_b32 v37, 16, v37
    v_mul_u32_u24 v38, 20, v37
    v_sub_u32 v36, v36, v38
    v_lshrrev_b32 v38, 1, v37
    v_and_b32 v38, 2, v38
    v_xor_b32 v36, v36, v38
    v_mul_u32_u24 v37, 1280, v37
    v_lshl_add_u32 v232, v36, 4, v37
    v_add_u32 v36, 64, v1
    v_mul_u32_u24 v37, 3277, v36
    v_lshrrev_b32 v37, 16, v37
    v_mul_u32_u24 v38, 20, v37
    v_sub_u32 v36, v36, v38
    v_lshrrev_b32 v38, 1, v37
    v_and_b32 v38, 2, v38
    v_xor_b32 v36, v36, v38
    v_mul_u32_u24 v37, 1280, v37
    v_lshl_add_u32 v233, v36, 4, v37
    v_add_u32 v36, 128, v1
    v_mul_u32_u24 v37, 3277, v36
    v_lshrrev_b32 v37, 16, v37
    v_mul_u32_u24 v38, 20, v37
    v_sub_u32 v36, v36, v38
    v_lshrrev_b32 v38, 1, v37
    v_and_b32 v38, 2, v38
    v_xor_b32 v36, v36, v38
    v_mul_u32_u24 v37, 1280, v37
    v_lshl_add_u32 v234, v36, 4, v37
    v_add_u32 v36, 192, v1
    v_mul_u32_u24 v37, 3277, v36
    v_lshrrev_b32 v37, 16, v37
    v_mul_u32_u24 v38, 20, v37
    v_sub_u32 v36, v36, v38
    v_lshrrev_b32 v38, 1, v37
    v_and_b32 v38, 2, v38
    v_xor_b32 v36, v36, v38
    v_mul_u32_u24 v37, 1280, v37
    v_lshl_add_u32 v235, v36, 4, v37
    v_add_u32 v36, 256, v1
    v_mul_u32_u24 v37, 3277, v36
    v_lshrrev_b32 v37, 16, v37
    v_mul_u32_u24 v38, 20, v37
    v_sub_u32 v36, v36, v38
    v_lshrrev_b32 v38, 1, v37
    v_and_b32 v38, 2, v38
    v_xor_b32 v36, v36, v38
    v_mul_u32_u24 v37, 1280, v37
    v_lshl_add_u32 v236, v36, 4, v37
    s_mov_b32 s64, s28
    s_mov_b32 s65, s29
    s_mov_b32 s66, 0x1e0000
    s_mov_b32 s67, 0x20000
    s_mul_i32 s10, s48, 7680
    v_bfe_u32 v36, v1, 2, 4
    v_mul_u32_u24 v36, 320, v36
    v_and_b32 v37, 3, v1
    v_lshl_add_u32 v36, v37, 3, v36
    v_and_b32 v37, 16, v1
    v_lshlrev_b32 v37, 1, v37
    s_xor_b32 s23, s15, 0
    s_mul_i32 s23, s23, 160
    v_xor_b32 v38, s23, v37
    v_add_u32 v248, v36, v38
    s_add_u32 s23, s23, 32
    v_xor_b32 v38, s23, v37
    v_add_u32 v249, v36, v38
    s_xor_b32 s23, s15, 1
    s_mul_i32 s23, s23, 160
    v_xor_b32 v38, s23, v37
    v_add_u32 v250, v36, v38
    s_add_u32 s23, s23, 32
    v_xor_b32 v38, s23, v37
    v_add_u32 v251, v36, v38
    v_add_u32 v252, 69760, v248
    v_add_u32 v253, 69760, v249
    v_add_u32 v254, 69760, v250
    v_add_u32 v255, 69760, v251
    s_lshl2_add_u32 s13, s44, s48
    s_lshl1_add_u32 s13, s13, s14
    s_mul_i32 s13, s13, 90112
    s_add_u32 s13, s13, 0x800000
    s_mul_i32 s16, s14, 180224
    s_sub_u32 s16, 90112, s16
    s_lshl2_add_u32 s23, s44, s46
    s_lshl_b32 s23, s23, 7
    s_add_u32 s23, s23, s48
    s_lshl_b32 s23, s23, 7
    s_add_u32 s23, s23, 0x100300
    v_and_b32 v36, 3, v1
    v_lshl_add_u32 v28, v36, 12, s23
    s_movk_i32 s18, 512
    v_mov_b32 v29, 156848
    v_lshl_add_u32 v29, s48, 2, v29
    v_and_b32 v36, 15, v1
    s_lshl_b32 s23, s14, 4
    v_xor_b32 v36, s23, v36
    s_lshl_b32 s23, s48, 7
    s_add_u32 s23, s23, 156928
    v_lshl_add_u32 v11, v36, 2, s23
    s_mul_i32 s23, s48, 1280
    s_add_u32 s23, s23, 147840
    v_lshl_add_u32 v36, v1, 2, s23
    ds_write_b32 v36, v232 offset:0
    ds_write_b32 v36, v233 offset:256
    ds_write_b32 v36, v234 offset:512
    ds_write_b32 v36, v235 offset:768
    ds_write_b32 v36, v236 offset:1024
    s_add_u32 m0, s7, 96512
    s_nop 0
    buffer_load_dwordx4 v8, s[60:63], s69 offen offset:0 lds
    buffer_load_dwordx4 v9, s[60:63], s69 offen offset:1024 lds
    buffer_load_dwordx4 v10, s[60:63], s69 offen offset:2048 lds
    s_add_u32 s69, s69, 196608
    s_add_u32 m0, s6, 69760
    s_nop 0
    buffer_load_dwordx4 v4, s[56:59], s68 offen offset:0 lds
    buffer_load_dwordx4 v5, s[56:59], s68 offen offset:1024 lds
    buffer_load_dwordx4 v6, s[56:59], s68 offen offset:2048 lds
    buffer_load_dwordx4 v7, s[56:59], s68 offen offset:3072 lds
    s_add_u32 s68, s68, 128
    s_waitcnt vmcnt(14)
    s_barrier
    ds_read_b128 v[88:91], v14 offset:0
    ds_read_b128 v[92:95], v15 offset:0
    ds_read_b64_tr_b16 v[96:97], v22 offset:0
    ds_read_b64_tr_b16 v[98:99], v22 offset:768
    ds_read_b64_tr_b16 v[100:101], v23 offset:32
    ds_read_b64_tr_b16 v[102:103], v23 offset:800
    ds_read_b64_tr_b16 v[104:105], v22 offset:64
    ds_read_b64_tr_b16 v[106:107], v22 offset:832
    ds_read_b64_tr_b16 v[108:109], v23 offset:96
    ds_read_b64_tr_b16 v[110:111], v23 offset:864
    s_waitcnt lgkmcnt(9)
    ds_read_b64_tr_b16 v[112:113], v22 offset:128
    ds_read_b64_tr_b16 v[114:115], v22 offset:896
    ds_read_b64_tr_b16 v[116:117], v23 offset:160
    ds_read_b64_tr_b16 v[118:119], v23 offset:928
    ds_read_b128 v[120:123], v26 offset:0
    s_waitcnt lgkmcnt(0)
    v_mfma_f32_16x16x32_bf16 v[240:243], v[120:123], v[88:91], 0
    ds_read_b128 v[124:127], v16 offset:0
    s_add_u32 m0, s7, 135552
    v_mfma_f32_16x16x32_bf16 v[244:247], v[120:123], v[92:95], 0
    ds_read_b128 v[128:131], v17 offset:0
    s_nop 0
    v_mfma_f32_16x16x32_bf16 v[40:43], v[96:99], v[88:91], 0
    ds_read_b64_tr_b16 v[132:133], v22 offset:6144
    buffer_load_dwordx4 v8, s[60:63], s69 offen offset:0 lds
    v_mfma_f32_16x16x32_bf16 v[44:47], v[96:99], v[92:95], 0
    ds_read_b64_tr_b16 v[134:135], v22 offset:6912
    buffer_load_dwordx4 v9, s[60:63], s69 offen offset:1024 lds
    v_mfma_f32_16x16x32_bf16 v[48:51], v[100:103], v[88:91], 0
    ds_read_b64_tr_b16 v[136:137], v23 offset:6176
    buffer_load_dwordx4 v10, s[60:63], s69 offen offset:2048 lds
    v_mfma_f32_16x16x32_bf16 v[52:55], v[100:103], v[92:95], 0
    ds_read_b64_tr_b16 v[138:139], v23 offset:6944
    s_add_u32 s69, s69, 196608
    v_mfma_f32_16x16x32_bf16 v[56:59], v[104:107], v[88:91], 0
    ds_read_b64_tr_b16 v[140:141], v22 offset:6208
    s_add_u32 m0, s6, 108800
    v_mfma_f32_16x16x32_bf16 v[60:63], v[104:107], v[92:95], 0
    ds_read_b64_tr_b16 v[142:143], v22 offset:6976
    ds_read_b64_tr_b16 v[144:145], v23 offset:6240
    v_mfma_f32_16x16x32_bf16 v[64:67], v[108:111], v[88:91], 0
    s_nop 0
    ds_read_b64_tr_b16 v[146:147], v23 offset:7008
    v_mfma_f32_16x16x32_bf16 v[68:71], v[108:111], v[92:95], 0
    buffer_load_dwordx4 v4, s[56:59], s68 offen offset:0 lds
    ds_read_b64_tr_b16 v[148:149], v22 offset:6272
    v_mfma_f32_16x16x32_bf16 v[72:75], v[112:115], v[88:91], 0
    buffer_load_dwordx4 v5, s[56:59], s68 offen offset:1024 lds
    ds_read_b64_tr_b16 v[150:151], v22 offset:7040
    v_mfma_f32_16x16x32_bf16 v[76:79], v[112:115], v[92:95], 0
    buffer_load_dwordx4 v6, s[56:59], s68 offen offset:2048 lds
    ds_read_b64_tr_b16 v[152:153], v23 offset:6304
    v_mfma_f32_16x16x32_bf16 v[80:83], v[116:119], v[88:91], 0
    buffer_load_dwordx4 v7, s[56:59], s68 offen offset:3072 lds
    ds_read_b64_tr_b16 v[154:155], v23 offset:7072
    v_mfma_f32_16x16x32_bf16 v[84:87], v[116:119], v[92:95], 0
    s_add_u32 s68, s68, 128
    ds_read_b128 v[156:159], v26 offset:64
    s_waitcnt vmcnt(7) lgkmcnt(0)
    s_barrier
    v_mfma_f32_16x16x32_bf16 v[240:243], v[156:159], v[124:127], v[240:243]
    ds_read_b128 v[88:91], v14 offset:39040
    s_add_u32 m0, s7, 57472
    v_mfma_f32_16x16x32_bf16 v[244:247], v[156:159], v[128:131], v[244:247]
    ds_read_b128 v[92:95], v15 offset:39040
    s_nop 0
    v_mfma_f32_16x16x32_bf16 v[40:43], v[132:135], v[124:127], v[40:43]
    ds_read_b64_tr_b16 v[96:97], v22 offset:39040
    ds_read_b64_tr_b16 v[98:99], v22 offset:39808
    v_mfma_f32_16x16x32_bf16 v[44:47], v[132:135], v[128:131], v[44:47]
    buffer_load_dwordx4 v8, s[60:63], s69 offen offset:0 lds
    v_mfma_f32_16x16x32_bf16 v[48:51], v[136:139], v[124:127], v[48:51]
    ds_read_b64_tr_b16 v[100:101], v23 offset:39072
    ds_read_b64_tr_b16 v[102:103], v23 offset:39840
    v_mfma_f32_16x16x32_bf16 v[52:55], v[136:139], v[128:131], v[52:55]
    buffer_load_dwordx4 v9, s[60:63], s69 offen offset:1024 lds
    ds_read_b64_tr_b16 v[104:105], v22 offset:39104
    v_mfma_f32_16x16x32_bf16 v[56:59], v[140:143], v[124:127], v[56:59]
    buffer_load_dwordx4 v10, s[60:63], s69 offen offset:2048 lds
    v_mfma_f32_16x16x32_bf16 v[60:63], v[140:143], v[128:131], v[60:63]
    ds_read_b64_tr_b16 v[106:107], v22 offset:39872
    ds_read_b64_tr_b16 v[108:109], v23 offset:39136
    v_mfma_f32_16x16x32_bf16 v[64:67], v[144:147], v[124:127], v[64:67]
    s_add_u32 s69, s69, 196608
    ds_read_b64_tr_b16 v[110:111], v23 offset:39904
    v_mfma_f32_16x16x32_bf16 v[68:71], v[144:147], v[128:131], v[68:71]
    ds_read_b64_tr_b16 v[112:113], v22 offset:39168
    s_add_u32 m0, s6, 30720
    v_mfma_f32_16x16x32_bf16 v[72:75], v[148:151], v[124:127], v[72:75]
    ds_read_b64_tr_b16 v[114:115], v22 offset:39936
    v_mfma_f32_16x16x32_bf16 v[76:79], v[148:151], v[128:131], v[76:79]
    s_nop 0
    ds_read_b64_tr_b16 v[116:117], v23 offset:39200
    v_mfma_f32_16x16x32_bf16 v[80:83], v[152:155], v[124:127], v[80:83]
    ds_read_b64_tr_b16 v[118:119], v23 offset:39968
    buffer_load_dwordx4 v4, s[56:59], s68 offen offset:0 lds
    v_mfma_f32_16x16x32_bf16 v[84:87], v[152:155], v[128:131], v[84:87]
    ds_read_b128 v[120:123], v26 offset:39040
    s_waitcnt lgkmcnt(0)
    v_mfma_f32_16x16x32_bf16 v[240:243], v[120:123], v[88:91], v[240:243]
    ds_read_b128 v[124:127], v16 offset:39040
    buffer_load_dwordx4 v5, s[56:59], s68 offen offset:1024 lds
    v_mfma_f32_16x16x32_bf16 v[244:247], v[120:123], v[92:95], v[244:247]
    ds_read_b128 v[128:131], v17 offset:39040
    v_mfma_f32_16x16x32_bf16 v[40:43], v[96:99], v[88:91], v[40:43]
    ds_read_b64_tr_b16 v[132:133], v22 offset:45184
    ds_read_b64_tr_b16 v[134:135], v22 offset:45952
    v_mfma_f32_16x16x32_bf16 v[44:47], v[96:99], v[92:95], v[44:47]
    buffer_load_dwordx4 v6, s[56:59], s68 offen offset:2048 lds
    v_mfma_f32_16x16x32_bf16 v[48:51], v[100:103], v[88:91], v[48:51]
    ds_read_b64_tr_b16 v[136:137], v23 offset:45216
    v_mfma_f32_16x16x32_bf16 v[52:55], v[100:103], v[92:95], v[52:55]
    ds_read_b64_tr_b16 v[138:139], v23 offset:45984
    ds_read_b64_tr_b16 v[140:141], v22 offset:45248
    v_mfma_f32_16x16x32_bf16 v[56:59], v[104:107], v[88:91], v[56:59]
    ds_read_b64_tr_b16 v[142:143], v22 offset:46016
    v_mfma_f32_16x16x32_bf16 v[60:63], v[104:107], v[92:95], v[60:63]
    buffer_load_dwordx4 v7, s[56:59], s68 offen offset:3072 lds
    v_mfma_f32_16x16x32_bf16 v[64:67], v[108:111], v[88:91], v[64:67]
    ds_read_b64_tr_b16 v[144:145], v23 offset:45280
    ds_read_b64_tr_b16 v[146:147], v23 offset:46048
    v_mfma_f32_16x16x32_bf16 v[68:71], v[108:111], v[92:95], v[68:71]
    ds_read_b64_tr_b16 v[148:149], v22 offset:45312
    v_mfma_f32_16x16x32_bf16 v[72:75], v[112:115], v[88:91], v[72:75]
    ds_read_b64_tr_b16 v[150:151], v22 offset:46080
    v_mfma_f32_16x16x32_bf16 v[76:79], v[112:115], v[92:95], v[76:79]
    s_add_u32 s68, s68, 128
    ds_read_b64_tr_b16 v[152:153], v23 offset:45344
    v_mfma_f32_16x16x32_bf16 v[80:83], v[116:119], v[88:91], v[80:83]
    ds_read_b64_tr_b16 v[154:155], v23 offset:46112
    v_mfma_f32_16x16x32_bf16 v[84:87], v[116:119], v[92:95], v[84:87]
    ds_read_b128 v[156:159], v26 offset:39104
    s_waitcnt vmcnt(7) lgkmcnt(0)
    s_barrier
    v_mfma_f32_16x16x32_bf16 v[240:243], v[156:159], v[124:127], v[240:243]
    ds_read_b128 v[88:91], v18 offset:0
    s_add_u32 m0, s7, 96512
    v_mfma_f32_16x16x32_bf16 v[244:247], v[156:159], v[128:131], v[244:247]
    ds_read_b128 v[92:95], v19 offset:0
    s_nop 0
    v_mfma_f32_16x16x32_bf16 v[40:43], v[132:135], v[124:127], v[40:43]
    ds_read_b64_tr_b16 v[96:97], v24 offset:0
    ds_read_b64_tr_b16 v[98:99], v24 offset:768
    v_mfma_f32_16x16x32_bf16 v[44:47], v[132:135], v[128:131], v[44:47]
    buffer_load_dwordx4 v8, s[60:63], s69 offen offset:0 lds
    v_mfma_f32_16x16x32_bf16 v[48:51], v[136:139], v[124:127], v[48:51]
    ds_read_b64_tr_b16 v[100:101], v25 offset:32
    ds_read_b64_tr_b16 v[102:103], v25 offset:800
    v_mfma_f32_16x16x32_bf16 v[52:55], v[136:139], v[128:131], v[52:55]
    buffer_load_dwordx4 v9, s[60:63], s69 offen offset:1024 lds
    ds_read_b64_tr_b16 v[104:105], v24 offset:64
    v_mfma_f32_16x16x32_bf16 v[56:59], v[140:143], v[124:127], v[56:59]
    buffer_load_dwordx4 v10, s[60:63], s69 offen offset:2048 lds
    v_mfma_f32_16x16x32_bf16 v[60:63], v[140:143], v[128:131], v[60:63]
    ds_read_b64_tr_b16 v[106:107], v24 offset:832
    ds_read_b64_tr_b16 v[108:109], v25 offset:96
    v_mfma_f32_16x16x32_bf16 v[64:67], v[144:147], v[124:127], v[64:67]
    s_add_u32 s69, s69, 196608
    ds_read_b64_tr_b16 v[110:111], v25 offset:864
    v_mfma_f32_16x16x32_bf16 v[68:71], v[144:147], v[128:131], v[68:71]
    ds_read_b64_tr_b16 v[112:113], v24 offset:128
    s_add_u32 m0, s6, 69760
    v_mfma_f32_16x16x32_bf16 v[72:75], v[148:151], v[124:127], v[72:75]
    ds_read_b64_tr_b16 v[114:115], v24 offset:896
    v_mfma_f32_16x16x32_bf16 v[76:79], v[148:151], v[128:131], v[76:79]
    s_nop 0
    ds_read_b64_tr_b16 v[116:117], v25 offset:160
    v_mfma_f32_16x16x32_bf16 v[80:83], v[152:155], v[124:127], v[80:83]
    ds_read_b64_tr_b16 v[118:119], v25 offset:928
    buffer_load_dwordx4 v4, s[56:59], s68 offen offset:0 lds
    v_mfma_f32_16x16x32_bf16 v[84:87], v[152:155], v[128:131], v[84:87]
    ds_read_b128 v[120:123], v27 offset:0
    s_waitcnt lgkmcnt(0)
    v_mfma_f32_16x16x32_bf16 v[240:243], v[120:123], v[88:91], v[240:243]
    ds_read_b128 v[124:127], v20 offset:0
    buffer_load_dwordx4 v5, s[56:59], s68 offen offset:1024 lds
    v_mfma_f32_16x16x32_bf16 v[244:247], v[120:123], v[92:95], v[244:247]
    ds_read_b128 v[128:131], v21 offset:0
    v_mfma_f32_16x16x32_bf16 v[40:43], v[96:99], v[88:91], v[40:43]
    ds_read_b64_tr_b16 v[132:133], v24 offset:6144
    ds_read_b64_tr_b16 v[134:135], v24 offset:6912
    v_mfma_f32_16x16x32_bf16 v[44:47], v[96:99], v[92:95], v[44:47]
    buffer_load_dwordx4 v6, s[56:59], s68 offen offset:2048 lds
    v_mfma_f32_16x16x32_bf16 v[48:51], v[100:103], v[88:91], v[48:51]
    ds_read_b64_tr_b16 v[136:137], v25 offset:6176
    v_mfma_f32_16x16x32_bf16 v[52:55], v[100:103], v[92:95], v[52:55]
    ds_read_b64_tr_b16 v[138:139], v25 offset:6944
    ds_read_b64_tr_b16 v[140:141], v24 offset:6208
    v_mfma_f32_16x16x32_bf16 v[56:59], v[104:107], v[88:91], v[56:59]
    ds_read_b64_tr_b16 v[142:143], v24 offset:6976
    v_mfma_f32_16x16x32_bf16 v[60:63], v[104:107], v[92:95], v[60:63]
    buffer_load_dwordx4 v7, s[56:59], s68 offen offset:3072 lds
    v_mfma_f32_16x16x32_bf16 v[64:67], v[108:111], v[88:91], v[64:67]
    ds_read_b64_tr_b16 v[144:145], v25 offset:6240
    ds_read_b64_tr_b16 v[146:147], v25 offset:7008
    v_mfma_f32_16x16x32_bf16 v[68:71], v[108:111], v[92:95], v[68:71]
    ds_read_b64_tr_b16 v[148:149], v24 offset:6272
    v_mfma_f32_16x16x32_bf16 v[72:75], v[112:115], v[88:91], v[72:75]
    ds_read_b64_tr_b16 v[150:151], v24 offset:7040
    v_mfma_f32_16x16x32_bf16 v[76:79], v[112:115], v[92:95], v[76:79]
    s_add_u32 s68, s68, 128
    ds_read_b64_tr_b16 v[152:153], v25 offset:6304
    v_mfma_f32_16x16x32_bf16 v[80:83], v[116:119], v[88:91], v[80:83]
    ds_read_b64_tr_b16 v[154:155], v25 offset:7072
    v_mfma_f32_16x16x32_bf16 v[84:87], v[116:119], v[92:95], v[84:87]
    ds_read_b128 v[156:159], v27 offset:64
    s_waitcnt vmcnt(7) lgkmcnt(0)
    s_barrier
    v_mfma_f32_16x16x32_bf16 v[240:243], v[156:159], v[124:127], v[240:243]
    ds_read_b128 v[88:91], v14 offset:0
    s_add_u32 m0, s7, 135552
    v_mfma_f32_16x16x32_bf16 v[244:247], v[156:159], v[128:131], v[244:247]
    ds_read_b128 v[92:95], v15 offset:0
    s_nop 0
    v_mfma_f32_16x16x32_bf16 v[40:43], v[132:135], v[124:127], v[40:43]
    ds_read_b64_tr_b16 v[96:97], v22 offset:0
    ds_read_b64_tr_b16 v[98:99], v22 offset:768
    v_mfma_f32_16x16x32_bf16 v[44:47], v[132:135], v[128:131], v[44:47]
    buffer_load_dwordx4 v8, s[60:63], s69 offen offset:0 lds
    v_mfma_f32_16x16x32_bf16 v[48:51], v[136:139], v[124:127], v[48:51]
    ds_read_b64_tr_b16 v[100:101], v23 offset:32
    ds_read_b64_tr_b16 v[102:103], v23 offset:800
    v_mfma_f32_16x16x32_bf16 v[52:55], v[136:139], v[128:131], v[52:55]
    buffer_load_dwordx4 v9, s[60:63], s69 offen offset:1024 lds
    ds_read_b64_tr_b16 v[104:105], v22 offset:64
    v_mfma_f32_16x16x32_bf16 v[56:59], v[140:143], v[124:127], v[56:59]
    buffer_load_dwordx4 v10, s[60:63], s69 offen offset:2048 lds
    v_mfma_f32_16x16x32_bf16 v[60:63], v[140:143], v[128:131], v[60:63]
    ds_read_b64_tr_b16 v[106:107], v22 offset:832
    ds_read_b64_tr_b16 v[108:109], v23 offset:96
    v_mfma_f32_16x16x32_bf16 v[64:67], v[144:147], v[124:127], v[64:67]
    s_add_u32 s69, s69, 196608
    ds_read_b64_tr_b16 v[110:111], v23 offset:864
    v_mfma_f32_16x16x32_bf16 v[68:71], v[144:147], v[128:131], v[68:71]
    ds_read_b64_tr_b16 v[112:113], v22 offset:128
    s_add_u32 m0, s6, 108800
    v_mfma_f32_16x16x32_bf16 v[72:75], v[148:151], v[124:127], v[72:75]
    ds_read_b64_tr_b16 v[114:115], v22 offset:896
    v_mfma_f32_16x16x32_bf16 v[76:79], v[148:151], v[128:131], v[76:79]
    s_nop 0
    ds_read_b64_tr_b16 v[116:117], v23 offset:160
    v_mfma_f32_16x16x32_bf16 v[80:83], v[152:155], v[124:127], v[80:83]
    ds_read_b64_tr_b16 v[118:119], v23 offset:928
    buffer_load_dwordx4 v4, s[56:59], s68 offen offset:0 lds
    v_mfma_f32_16x16x32_bf16 v[84:87], v[152:155], v[128:131], v[84:87]
    ds_read_b128 v[120:123], v26 offset:0
    s_waitcnt lgkmcnt(0)
    v_mfma_f32_16x16x32_bf16 v[240:243], v[120:123], v[88:91], v[240:243]
    ds_read_b128 v[124:127], v16 offset:0
    buffer_load_dwordx4 v5, s[56:59], s68 offen offset:1024 lds
    ds_read_b128 v[128:131], v17 offset:0
    v_mfma_f32_16x16x32_bf16 v[244:247], v[120:123], v[92:95], v[244:247]
    buffer_load_dwordx4 v6, s[56:59], s68 offen offset:2048 lds
    ds_read_b64_tr_b16 v[132:133], v22 offset:6144
    v_mfma_f32_16x16x32_bf16 v[40:43], v[96:99], v[88:91], v[40:43]
    buffer_load_dwordx4 v7, s[56:59], s68 offen offset:3072 lds
    ds_read_b64_tr_b16 v[134:135], v22 offset:6912
    v_mfma_f32_16x16x32_bf16 v[44:47], v[96:99], v[92:95], v[44:47]
    s_add_u32 s68, s68, 128
    ds_read_b64_tr_b16 v[136:137], v23 offset:6176
    v_mfma_f32_16x16x32_bf16 v[48:51], v[100:103], v[88:91], v[48:51]
    v_cmp_gt_u32 vcc, 16, v1
    ds_read_b64_tr_b16 v[138:139], v23 offset:6944
    v_mfma_f32_16x16x32_bf16 v[52:55], v[100:103], v[92:95], v[52:55]
    v_readfirstlane_b32 s49, v3
    ds_read_b64_tr_b16 v[140:141], v22 offset:6208
    v_mfma_f32_16x16x32_bf16 v[56:59], v[104:107], v[88:91], v[56:59]
    s_nop 3
    ds_read_b64_tr_b16 v[142:143], v22 offset:6976
    v_mfma_f32_16x16x32_bf16 v[60:63], v[104:107], v[92:95], v[60:63]
    s_mul_i32 s49, s49, 0x9e3779b1
    ds_read_b64_tr_b16 v[144:145], v23 offset:6240
    s_add_u32 s49, s49, 0x7f4a7c15
    v_mfma_f32_16x16x32_bf16 v[64:67], v[108:111], v[88:91], v[64:67]
    ds_read_b64_tr_b16 v[146:147], v23 offset:7008
    v_cndmask_b32 v200, 0, v200, vcc
    v_mfma_f32_16x16x32_bf16 v[68:71], v[108:111], v[92:95], v[68:71]
    ds_read_b64_tr_b16 v[148:149], v22 offset:6272
    v_cndmask_b32 v204, 0, v204, vcc
    v_mfma_f32_16x16x32_bf16 v[72:75], v[112:115], v[88:91], v[72:75]
    ds_read_b64_tr_b16 v[150:151], v22 offset:7040
    v_cndmask_b32 v208, 0, v208, vcc
    v_mfma_f32_16x16x32_bf16 v[76:79], v[112:115], v[92:95], v[76:79]
    ds_read_b64_tr_b16 v[152:153], v23 offset:6304
    v_cndmask_b32 v212, 0, v212, vcc
    v_mfma_f32_16x16x32_bf16 v[80:83], v[116:119], v[88:91], v[80:83]
    ds_read_b64_tr_b16 v[154:155], v23 offset:7072
    v_cndmask_b32 v216, 0, v216, vcc
    v_mfma_f32_16x16x32_bf16 v[84:87], v[116:119], v[92:95], v[84:87]
    ds_read_b128 v[156:159], v26 offset:64
    v_cndmask_b32 v220, 0, v220, vcc
    s_waitcnt vmcnt(7) lgkmcnt(0)
    s_barrier
    v_mfma_f32_16x16x32_bf16 v[240:243], v[156:159], v[124:127], v[240:243]
    ds_read_b128 v[88:91], v14 offset:39040
    s_add_u32 m0, s7, 57472
    v_mfma_f32_16x16x32_bf16 v[244:247], v[156:159], v[128:131], v[244:247]
    ds_read_b128 v[92:95], v15 offset:39040
    s_nop 0
    v_mfma_f32_16x16x32_bf16 v[40:43], v[132:135], v[124:127], v[40:43]
    ds_read_b64_tr_b16 v[96:97], v22 offset:39040
    ds_read_b64_tr_b16 v[98:99], v22 offset:39808
    v_mfma_f32_16x16x32_bf16 v[44:47], v[132:135], v[128:131], v[44:47]
    buffer_load_dwordx4 v8, s[60:63], s69 offen offset:0 lds
    v_mfma_f32_16x16x32_bf16 v[48:51], v[136:139], v[124:127], v[48:51]
    ds_read_b64_tr_b16 v[100:101], v23 offset:39072
    ds_read_b64_tr_b16 v[102:103], v23 offset:39840
    v_mfma_f32_16x16x32_bf16 v[52:55], v[136:139], v[128:131], v[52:55]
    buffer_load_dwordx4 v9, s[60:63], s69 offen offset:1024 lds
    ds_read_b64_tr_b16 v[104:105], v22 offset:39104
    v_mfma_f32_16x16x32_bf16 v[56:59], v[140:143], v[124:127], v[56:59]
    buffer_load_dwordx4 v10, s[60:63], s69 offen offset:2048 lds
    v_mfma_f32_16x16x32_bf16 v[60:63], v[140:143], v[128:131], v[60:63]
    ds_read_b64_tr_b16 v[106:107], v22 offset:39872
    ds_read_b64_tr_b16 v[108:109], v23 offset:39136
    v_mfma_f32_16x16x32_bf16 v[64:67], v[144:147], v[124:127], v[64:67]
    s_add_u32 s69, s69, 196608
    ds_read_b64_tr_b16 v[110:111], v23 offset:39904
    v_mfma_f32_16x16x32_bf16 v[68:71], v[144:147], v[128:131], v[68:71]
    ds_read_b64_tr_b16 v[112:113], v22 offset:39168
    s_add_u32 m0, s6, 30720
    v_mfma_f32_16x16x32_bf16 v[72:75], v[148:151], v[124:127], v[72:75]
    ds_read_b64_tr_b16 v[114:115], v22 offset:39936
    v_mfma_f32_16x16x32_bf16 v[76:79], v[148:151], v[128:131], v[76:79]
    s_nop 0
    ds_read_b64_tr_b16 v[116:117], v23 offset:39200
    v_mfma_f32_16x16x32_bf16 v[80:83], v[152:155], v[124:127], v[80:83]
    ds_read_b64_tr_b16 v[118:119], v23 offset:39968
    buffer_load_dwordx4 v4, s[56:59], s68 offen offset:0 lds
    v_mfma_f32_16x16x32_bf16 v[84:87], v[152:155], v[128:131], v[84:87]
    ds_read_b128 v[120:123], v26 offset:39040
    s_waitcnt lgkmcnt(0)
    v_mfma_f32_16x16x32_bf16 v[240:243], v[120:123], v[88:91], v[240:243]
    ds_read_b128 v[124:127], v16 offset:39040
    v_mfma_f32_16x16x32_bf16 v[244:247], v[120:123], v[92:95], v[244:247]
    buffer_load_dwordx4 v5, s[56:59], s68 offen offset:1024 lds
    v_mfma_f32_16x16x32_bf16 v[40:43], v[96:99], v[88:91], v[40:43]
    ds_read_b128 v[128:131], v17 offset:39040
    v_mfma_f32_16x16x32_bf16 v[44:47], v[96:99], v[92:95], v[44:47]
    v_mfma_f32_16x16x32_bf16 v[48:51], v[100:103], v[88:91], v[48:51]
    ds_read_b64_tr_b16 v[132:133], v22 offset:45184
    v_mfma_f32_16x16x32_bf16 v[52:55], v[100:103], v[92:95], v[52:55]
    ds_read_b64_tr_b16 v[134:135], v22 offset:45952
    v_mfma_f32_16x16x32_bf16 v[56:59], v[104:107], v[88:91], v[56:59]
    buffer_load_dwordx4 v6, s[56:59], s68 offen offset:2048 lds
    v_mfma_f32_16x16x32_bf16 v[60:63], v[104:107], v[92:95], v[60:63]
    v_mfma_f32_16x16x32_bf16 v[64:67], v[108:111], v[88:91], v[64:67]
    ds_read_b64_tr_b16 v[136:137], v23 offset:45216
    v_mfma_f32_16x16x32_bf16 v[68:71], v[108:111], v[92:95], v[68:71]
    ds_read_b64_tr_b16 v[138:139], v23 offset:45984
    v_mfma_f32_16x16x32_bf16 v[72:75], v[112:115], v[88:91], v[72:75]
    ds_read_b64_tr_b16 v[140:141], v22 offset:45248
    v_mfma_f32_16x16x32_bf16 v[76:79], v[112:115], v[92:95], v[76:79]
    v_mfma_f32_16x16x32_bf16 v[80:83], v[116:119], v[88:91], v[80:83]
    ds_read_b64_tr_b16 v[142:143], v22 offset:46016
    v_mfma_f32_16x16x32_bf16 v[84:87], v[116:119], v[92:95], v[84:87]
    buffer_load_dwordx4 v7, s[56:59], s68 offen offset:3072 lds
    v_mfma_f32_16x16x32_bf16 v[40:43], v[200:203], v[224:227], v[40:43]
    v_mfma_f32_16x16x32_bf16 v[44:47], v[200:203], v[224:227], v[44:47]
    ds_read_b64_tr_b16 v[144:145], v23 offset:45280
    v_mfma_f32_16x16x32_bf16 v[48:51], v[204:207], v[224:227], v[48:51]
    ds_read_b64_tr_b16 v[146:147], v23 offset:46048
    v_mfma_f32_16x16x32_bf16 v[52:55], v[204:207], v[224:227], v[52:55]
    ds_read_b64_tr_b16 v[148:149], v22 offset:45312
    v_mfma_f32_16x16x32_bf16 v[56:59], v[208:211], v[224:227], v[56:59]
    v_mfma_f32_16x16x32_bf16 v[60:63], v[208:211], v[224:227], v[60:63]
    ds_read_b64_tr_b16 v[150:151], v22 offset:46080
    v_mfma_f32_16x16x32_bf16 v[64:67], v[212:215], v[224:227], v[64:67]
    s_add_u32 s68, s68, 128
    v_mfma_f32_16x16x32_bf16 v[68:71], v[212:215], v[224:227], v[68:71]
    ds_read_b64_tr_b16 v[152:153], v23 offset:45344
    v_mfma_f32_16x16x32_bf16 v[72:75], v[216:219], v[224:227], v[72:75]
    v_mfma_f32_16x16x32_bf16 v[76:79], v[216:219], v[224:227], v[76:79]
    ds_read_b64_tr_b16 v[154:155], v23 offset:46112
    v_mfma_f32_16x16x32_bf16 v[80:83], v[220:223], v[224:227], v[80:83]
    ds_read_b128 v[156:159], v26 offset:39104
    v_mfma_f32_16x16x32_bf16 v[84:87], v[220:223], v[224:227], v[84:87]
    s_waitcnt vmcnt(7) lgkmcnt(0)
    s_barrier
    v_mfma_f32_16x16x32_bf16 v[240:243], v[156:159], v[124:127], v[240:243]
    ds_read_b128 v[88:91], v18 offset:0
    s_add_u32 m0, s7, 96512
    v_mfma_f32_16x16x32_bf16 v[244:247], v[156:159], v[128:131], v[244:247]
    ds_read_b128 v[92:95], v19 offset:0
    s_nop 0
    v_mfma_f32_16x16x32_bf16 v[40:43], v[132:135], v[124:127], v[40:43]
    ds_read_b64_tr_b16 v[96:97], v24 offset:0
    ds_read_b64_tr_b16 v[98:99], v24 offset:768
    v_mfma_f32_16x16x32_bf16 v[44:47], v[132:135], v[128:131], v[44:47]
    buffer_load_dwordx4 v8, s[60:63], s69 offen offset:0 lds
    ds_read_b64_tr_b16 v[100:101], v25 offset:32
    v_mfma_f32_16x16x32_bf16 v[48:51], v[136:139], v[124:127], v[48:51]
    buffer_load_dwordx4 v9, s[60:63], s69 offen offset:1024 lds
    v_mfma_f32_16x16x32_bf16 v[52:55], v[136:139], v[128:131], v[52:55]
    ds_read_b64_tr_b16 v[102:103], v25 offset:800
    ds_read_b64_tr_b16 v[104:105], v24 offset:64
    v_mfma_f32_16x16x32_bf16 v[56:59], v[140:143], v[124:127], v[56:59]
    buffer_load_dwordx4 v10, s[60:63], s69 offen offset:2048 lds
    ds_read_b64_tr_b16 v[106:107], v24 offset:832
    v_mfma_f32_16x16x32_bf16 v[60:63], v[140:143], v[128:131], v[60:63]
    s_add_u32 s69, s69, 196608
    ds_read_b64_tr_b16 v[108:109], v25 offset:96
    v_mfma_f32_16x16x32_bf16 v[64:67], v[144:147], v[124:127], v[64:67]
    ds_read_b64_tr_b16 v[110:111], v25 offset:864
    s_add_u32 m0, s6, 69760
    v_mfma_f32_16x16x32_bf16 v[68:71], v[144:147], v[128:131], v[68:71]
    ds_read_b64_tr_b16 v[112:113], v24 offset:128
    v_mfma_f32_16x16x32_bf16 v[72:75], v[148:151], v[124:127], v[72:75]
    s_nop 0
    ds_read_b64_tr_b16 v[114:115], v24 offset:896
    v_mfma_f32_16x16x32_bf16 v[76:79], v[148:151], v[128:131], v[76:79]
    ds_read_b64_tr_b16 v[116:117], v25 offset:160
    buffer_load_dwordx4 v4, s[56:59], s68 offen offset:0 lds
    v_mfma_f32_16x16x32_bf16 v[80:83], v[152:155], v[124:127], v[80:83]
    ds_read_b64_tr_b16 v[118:119], v25 offset:928
    buffer_load_dwordx4 v5, s[56:59], s68 offen offset:1024 lds
    v_mfma_f32_16x16x32_bf16 v[84:87], v[152:155], v[128:131], v[84:87]
    ds_read_b128 v[120:123], v27 offset:0
    s_waitcnt lgkmcnt(0)
    v_mfma_f32_16x16x32_bf16 v[240:243], v[120:123], v[88:91], v[240:243]
    ds_read_b128 v[124:127], v20 offset:0
    buffer_load_dwordx4 v6, s[56:59], s68 offen offset:2048 lds
    buffer_load_dwordx4 v7, s[56:59], s68 offen offset:3072 lds
    v_mfma_f32_16x16x32_bf16 v[244:247], v[120:123], v[92:95], v[244:247]
    ds_read_b128 v[128:131], v21 offset:0
    s_add_u32 s68, s68, 128
    v_mfma_f32_16x16x32_bf16 v[40:43], v[96:99], v[88:91], v[40:43]
    ds_read_b64_tr_b16 v[132:133], v24 offset:6144
    s_add_u32 s8, s47, 0
    v_mfma_f32_16x16x32_bf16 v[44:47], v[96:99], v[92:95], v[44:47]
    ds_read_b64_tr_b16 v[134:135], v24 offset:6912
    s_and_b32 s8, s8, 3
    ds_read_b64_tr_b16 v[136:137], v25 offset:6176
    v_mfma_f32_16x16x32_bf16 v[48:51], v[100:103], v[88:91], v[48:51]
    s_lshl2_add_u32 s8, s46, s8
    ds_read_b64_tr_b16 v[138:139], v25 offset:6944
    v_mfma_f32_16x16x32_bf16 v[52:55], v[100:103], v[92:95], v[52:55]
    s_lshl2_add_u32 s8, s8, s48
    ds_read_b64_tr_b16 v[140:141], v24 offset:6208
    v_mfma_f32_16x16x32_bf16 v[56:59], v[104:107], v[88:91], v[56:59]
    s_mul_i32 s8, s8, 30720
    ds_read_b64_tr_b16 v[142:143], v24 offset:6976
    v_mfma_f32_16x16x32_bf16 v[60:63], v[104:107], v[92:95], v[60:63]
    s_mul_i32 s9, s47, 320
    s_add_u32 s8, s8, s9
    ds_read_b64_tr_b16 v[144:145], v25 offset:6240
    v_mfma_f32_16x16x32_bf16 v[64:67], v[108:111], v[88:91], v[64:67]
    s_add_u32 s9, s8, 20480
    ds_read_b64_tr_b16 v[146:147], v25 offset:7008
    v_mfma_f32_16x16x32_bf16 v[68:71], v[108:111], v[92:95], v[68:71]
    s_add_u32 m0, s10, 0
    ds_read_b64_tr_b16 v[148:149], v24 offset:6272
    v_mfma_f32_16x16x32_bf16 v[72:75], v[112:115], v[88:91], v[72:75]
    s_nop 0
    buffer_load_dwordx4 v232, s[64:67], s8 offen lds
    ds_read_b64_tr_b16 v[150:151], v24 offset:7040
    s_add_u32 m0, s10, 1024
    v_mfma_f32_16x16x32_bf16 v[76:79], v[112:115], v[92:95], v[76:79]
    ds_read_b64_tr_b16 v[152:153], v25 offset:6304
    s_nop 0
    buffer_load_dwordx4 v233, s[64:67], s8 offen lds
    v_mfma_f32_16x16x32_bf16 v[80:83], v[116:119], v[88:91], v[80:83]
    ds_read_b64_tr_b16 v[154:155], v25 offset:7072
    s_add_u32 m0, s10, 2048
    v_mfma_f32_16x16x32_bf16 v[84:87], v[116:119], v[92:95], v[84:87]
    ds_read_b128 v[156:159], v27 offset:64
    s_nop 0
    buffer_load_dwordx4 v234, s[64:67], s8 offen lds
    s_waitcnt vmcnt(10) lgkmcnt(0)
    s_barrier
    v_mfma_f32_16x16x32_bf16 v[240:243], v[156:159], v[124:127], v[240:243]
    ds_read_b128 v[88:91], v14 offset:0
    s_add_u32 m0, s7, 135552
    v_mfma_f32_16x16x32_bf16 v[244:247], v[156:159], v[128:131], v[244:247]
    ds_read_b128 v[92:95], v15 offset:0
    s_nop 0
    v_mfma_f32_16x16x32_bf16 v[40:43], v[132:135], v[124:127], v[40:43]
    ds_read_b64_tr_b16 v[96:97], v22 offset:0
    ds_read_b64_tr_b16 v[98:99], v22 offset:768
    v_mfma_f32_16x16x32_bf16 v[44:47], v[132:135], v[128:131], v[44:47]
    buffer_load_dwordx4 v8, s[60:63], s69 offen offset:0 lds
    ds_read_b64_tr_b16 v[100:101], v23 offset:32
    v_mfma_f32_16x16x32_bf16 v[48:51], v[136:139], v[124:127], v[48:51]
    buffer_load_dwordx4 v9, s[60:63], s69 offen offset:1024 lds
    v_mfma_f32_16x16x32_bf16 v[52:55], v[136:139], v[128:131], v[52:55]
    ds_read_b64_tr_b16 v[102:103], v23 offset:800
    ds_read_b64_tr_b16 v[104:105], v22 offset:64
    v_mfma_f32_16x16x32_bf16 v[56:59], v[140:143], v[124:127], v[56:59]
    buffer_load_dwordx4 v10, s[60:63], s69 offen offset:2048 lds
    ds_read_b64_tr_b16 v[106:107], v22 offset:832
    v_mfma_f32_16x16x32_bf16 v[60:63], v[140:143], v[128:131], v[60:63]
    s_add_u32 s69, s69, 196608
    ds_read_b64_tr_b16 v[108:109], v23 offset:96
    v_mfma_f32_16x16x32_bf16 v[64:67], v[144:147], v[124:127], v[64:67]
    ds_read_b64_tr_b16 v[110:111], v23 offset:864
    s_add_u32 m0, s6, 108800
    v_mfma_f32_16x16x32_bf16 v[68:71], v[144:147], v[128:131], v[68:71]
    ds_read_b64_tr_b16 v[112:113], v22 offset:128
    v_mfma_f32_16x16x32_bf16 v[72:75], v[148:151], v[124:127], v[72:75]
    s_nop 0
    ds_read_b64_tr_b16 v[114:115], v22 offset:896
    v_mfma_f32_16x16x32_bf16 v[76:79], v[148:151], v[128:131], v[76:79]
    ds_read_b64_tr_b16 v[116:117], v23 offset:160
    buffer_load_dwordx4 v4, s[56:59], s68 offen offset:0 lds
    v_mfma_f32_16x16x32_bf16 v[80:83], v[152:155], v[124:127], v[80:83]
    ds_read_b64_tr_b16 v[118:119], v23 offset:928
    buffer_load_dwordx4 v5, s[56:59], s68 offen offset:1024 lds
    v_mfma_f32_16x16x32_bf16 v[84:87], v[152:155], v[128:131], v[84:87]
    ds_read_b128 v[120:123], v26 offset:0
    s_waitcnt lgkmcnt(0)
    v_mfma_f32_16x16x32_bf16 v[240:243], v[120:123], v[88:91], v[240:243]
    ds_read_b128 v[124:127], v16 offset:0
    buffer_load_dwordx4 v6, s[56:59], s68 offen offset:2048 lds
    v_mfma_f32_16x16x32_bf16 v[244:247], v[120:123], v[92:95], v[244:247]
    ds_read_b128 v[128:131], v17 offset:0
    buffer_load_dwordx4 v7, s[56:59], s68 offen offset:3072 lds
    v_mfma_f32_16x16x32_bf16 v[40:43], v[96:99], v[88:91], v[40:43]
    ds_read_b64_tr_b16 v[132:133], v22 offset:6144
    ds_read_b64_tr_b16 v[134:135], v22 offset:6912
    v_mfma_f32_16x16x32_bf16 v[44:47], v[96:99], v[92:95], v[44:47]
    s_add_u32 s68, s68, 128
    v_mfma_f32_16x16x32_bf16 v[48:51], v[100:103], v[88:91], v[48:51]
    ds_read_b64_tr_b16 v[136:137], v23 offset:6176
    ds_read_b64_tr_b16 v[138:139], v23 offset:6944
    v_mfma_f32_16x16x32_bf16 v[52:55], v[100:103], v[92:95], v[52:55]
    s_add_u32 m0, s10, 3072
    ds_read_b64_tr_b16 v[140:141], v22 offset:6208
    v_mfma_f32_16x16x32_bf16 v[56:59], v[104:107], v[88:91], v[56:59]
    s_nop 0
    buffer_load_dwordx4 v235, s[64:67], s8 offen lds
    v_mfma_f32_16x16x32_bf16 v[60:63], v[104:107], v[92:95], v[60:63]
    ds_read_b64_tr_b16 v[142:143], v22 offset:6976
    ds_read_b64_tr_b16 v[144:145], v23 offset:6240
    v_mfma_f32_16x16x32_bf16 v[64:67], v[108:111], v[88:91], v[64:67]
    s_add_u32 m0, s10, 4096
    ds_read_b64_tr_b16 v[146:147], v23 offset:7008
    v_mfma_f32_16x16x32_bf16 v[68:71], v[108:111], v[92:95], v[68:71]
    ds_read_b64_tr_b16 v[148:149], v22 offset:6272
    s_nop 0
    buffer_load_dwordx4 v236, s[64:67], s8 offen lds
    v_mfma_f32_16x16x32_bf16 v[72:75], v[112:115], v[88:91], v[72:75]
    ds_read_b64_tr_b16 v[150:151], v22 offset:7040
    v_mfma_f32_16x16x32_bf16 v[76:79], v[112:115], v[92:95], v[76:79]
    s_add_u32 m0, s10, 5120
    ds_read_b64_tr_b16 v[152:153], v23 offset:6304
    v_mfma_f32_16x16x32_bf16 v[80:83], v[116:119], v[88:91], v[80:83]
    ds_read_b64_tr_b16 v[154:155], v23 offset:7072
    s_nop 0
    buffer_load_dwordx4 v232, s[64:67], s9 offen lds
    v_mfma_f32_16x16x32_bf16 v[84:87], v[116:119], v[92:95], v[84:87]
    ds_read_b128 v[156:159], v26 offset:64
    s_waitcnt vmcnt(13) lgkmcnt(0)
    s_barrier
    v_mfma_f32_16x16x32_bf16 v[240:243], v[156:159], v[124:127], v[240:243]
    ds_read_b128 v[88:91], v14 offset:39040
    s_add_u32 m0, s7, 57472
    v_mfma_f32_16x16x32_bf16 v[244:247], v[156:159], v[128:131], v[244:247]
    ds_read_b128 v[92:95], v15 offset:39040
    s_nop 0
    v_mfma_f32_16x16x32_bf16 v[40:43], v[132:135], v[124:127], v[40:43]
    ds_read_b64_tr_b16 v[96:97], v22 offset:39040
    ds_read_b64_tr_b16 v[98:99], v22 offset:39808
    v_mfma_f32_16x16x32_bf16 v[44:47], v[132:135], v[128:131], v[44:47]
    buffer_load_dwordx4 v8, s[60:63], s69 offen offset:0 lds
    ds_read_b64_tr_b16 v[100:101], v23 offset:39072
    v_mfma_f32_16x16x32_bf16 v[48:51], v[136:139], v[124:127], v[48:51]
    buffer_load_dwordx4 v9, s[60:63], s69 offen offset:1024 lds
    v_mfma_f32_16x16x32_bf16 v[52:55], v[136:139], v[128:131], v[52:55]
    ds_read_b64_tr_b16 v[102:103], v23 offset:39840
    ds_read_b64_tr_b16 v[104:105], v22 offset:39104
    v_mfma_f32_16x16x32_bf16 v[56:59], v[140:143], v[124:127], v[56:59]
    buffer_load_dwordx4 v10, s[60:63], s69 offen offset:2048 lds
    ds_read_b64_tr_b16 v[106:107], v22 offset:39872
    v_mfma_f32_16x16x32_bf16 v[60:63], v[140:143], v[128:131], v[60:63]
    s_add_u32 s69, s69, 196608
    ds_read_b64_tr_b16 v[108:109], v23 offset:39136
    v_mfma_f32_16x16x32_bf16 v[64:67], v[144:147], v[124:127], v[64:67]
    ds_read_b64_tr_b16 v[110:111], v23 offset:39904
    s_add_u32 m0, s6, 30720
    v_mfma_f32_16x16x32_bf16 v[68:71], v[144:147], v[128:131], v[68:71]
    ds_read_b64_tr_b16 v[112:113], v22 offset:39168
    v_mfma_f32_16x16x32_bf16 v[72:75], v[148:151], v[124:127], v[72:75]
    s_nop 0
    ds_read_b64_tr_b16 v[114:115], v22 offset:39936
    v_mfma_f32_16x16x32_bf16 v[76:79], v[148:151], v[128:131], v[76:79]
    ds_read_b64_tr_b16 v[116:117], v23 offset:39200
    buffer_load_dwordx4 v4, s[56:59], s68 offen offset:0 lds
    v_mfma_f32_16x16x32_bf16 v[80:83], v[152:155], v[124:127], v[80:83]
    ds_read_b64_tr_b16 v[118:119], v23 offset:39968
    buffer_load_dwordx4 v5, s[56:59], s68 offen offset:1024 lds
    v_mfma_f32_16x16x32_bf16 v[84:87], v[152:155], v[128:131], v[84:87]
    ds_read_b128 v[120:123], v26 offset:39040
    s_waitcnt lgkmcnt(0)
    v_mfma_f32_16x16x32_bf16 v[240:243], v[120:123], v[88:91], v[240:243]
    ds_read_b128 v[124:127], v16 offset:39040
    buffer_load_dwordx4 v6, s[56:59], s68 offen offset:2048 lds
    v_mfma_f32_16x16x32_bf16 v[244:247], v[120:123], v[92:95], v[244:247]
    ds_read_b128 v[128:131], v17 offset:39040
    ds_read_b64_tr_b16 v[132:133], v22 offset:45184
    v_mfma_f32_16x16x32_bf16 v[40:43], v[96:99], v[88:91], v[40:43]
    buffer_load_dwordx4 v7, s[56:59], s68 offen offset:3072 lds
    v_mfma_f32_16x16x32_bf16 v[44:47], v[96:99], v[92:95], v[44:47]
    ds_read_b64_tr_b16 v[134:135], v22 offset:45952
    ds_read_b64_tr_b16 v[136:137], v23 offset:45216
    v_mfma_f32_16x16x32_bf16 v[48:51], v[100:103], v[88:91], v[48:51]
    s_add_u32 s68, s68, 128
    v_mfma_f32_16x16x32_bf16 v[52:55], v[100:103], v[92:95], v[52:55]
    ds_read_b64_tr_b16 v[138:139], v23 offset:45984
    ds_read_b64_tr_b16 v[140:141], v22 offset:45248
    v_mfma_f32_16x16x32_bf16 v[56:59], v[104:107], v[88:91], v[56:59]
    s_add_u32 m0, s10, 6144
    v_mfma_f32_16x16x32_bf16 v[60:63], v[104:107], v[92:95], v[60:63]
    ds_read_b64_tr_b16 v[142:143], v22 offset:46016
    ds_read_b64_tr_b16 v[144:145], v23 offset:45280
    v_mfma_f32_16x16x32_bf16 v[64:67], v[108:111], v[88:91], v[64:67]
    s_nop 0
    buffer_load_dwordx4 v233, s[64:67], s9 offen lds
    ds_read_b64_tr_b16 v[146:147], v23 offset:46048
    v_mfma_f32_16x16x32_bf16 v[68:71], v[108:111], v[92:95], v[68:71]
    ds_read_b64_tr_b16 v[148:149], v22 offset:45312
    v_mfma_f32_16x16x32_bf16 v[72:75], v[112:115], v[88:91], v[72:75]
    s_add_u32 m0, s10, 7168
    ds_read_b64_tr_b16 v[150:151], v22 offset:46080
    v_mfma_f32_16x16x32_bf16 v[76:79], v[112:115], v[92:95], v[76:79]
    ds_read_b64_tr_b16 v[152:153], v23 offset:45344
    v_mfma_f32_16x16x32_bf16 v[80:83], v[116:119], v[88:91], v[80:83]
    s_mov_b32 exec_hi, 0
    buffer_load_dwordx4 v234, s[64:67], s9 offen lds
    s_mov_b32 exec_hi, -1
    ds_read_b64_tr_b16 v[154:155], v23 offset:46112
    v_mfma_f32_16x16x32_bf16 v[84:87], v[116:119], v[92:95], v[84:87]
    ds_read_b128 v[156:159], v26 offset:39104
    s_waitcnt vmcnt(12) lgkmcnt(0)
    s_barrier
    v_mfma_f32_16x16x32_bf16 v[240:243], v[156:159], v[124:127], v[240:243]
    ds_read_b128 v[88:91], v18 offset:0
    s_add_u32 s8, s47, 1
    s_and_b32 s8, s8, 3
    v_mfma_f32_16x16x32_bf16 v[244:247], v[156:159], v[128:131], v[244:247]
    ds_read_b128 v[92:95], v19 offset:0
    s_lshl2_add_u32 s8, s46, s8
    v_mfma_f32_16x16x32_bf16 v[40:43], v[132:135], v[124:127], v[40:43]
    ds_read_b64_tr_b16 v[96:97], v24 offset:0
    s_lshl2_add_u32 s8, s8, s48
    v_mfma_f32_16x16x32_bf16 v[44:47], v[132:135], v[128:131], v[44:47]
    ds_read_b64_tr_b16 v[98:99], v24 offset:768
    s_mul_i32 s8, s8, 30720
    v_mfma_f32_16x16x32_bf16 v[48:51], v[136:139], v[124:127], v[48:51]
    ds_read_b64_tr_b16 v[100:101], v25 offset:32
    s_mul_i32 s9, s47, 320
    ds_read_b64_tr_b16 v[102:103], v25 offset:800
    v_mfma_f32_16x16x32_bf16 v[52:55], v[136:139], v[128:131], v[52:55]
    s_add_u32 s8, s8, s9
    ds_read_b64_tr_b16 v[104:105], v24 offset:64
    v_mfma_f32_16x16x32_bf16 v[56:59], v[140:143], v[124:127], v[56:59]
    s_add_u32 s9, s8, 20480
    ds_read_b64_tr_b16 v[106:107], v24 offset:832
    v_mfma_f32_16x16x32_bf16 v[60:63], v[140:143], v[128:131], v[60:63]
    s_add_u32 m0, s10, 69760
    ds_read_b64_tr_b16 v[108:109], v25 offset:96
    v_mfma_f32_16x16x32_bf16 v[64:67], v[144:147], v[124:127], v[64:67]
    s_nop 0
    buffer_load_dwordx4 v232, s[64:67], s8 offen lds
    ds_read_b64_tr_b16 v[110:111], v25 offset:864
    v_mfma_f32_16x16x32_bf16 v[68:71], v[144:147], v[128:131], v[68:71]
    s_add_u32 m0, s10, 70784
    ds_read_b64_tr_b16 v[112:113], v24 offset:128
    s_nop 0
    buffer_load_dwordx4 v233, s[64:67], s8 offen lds
    v_mfma_f32_16x16x32_bf16 v[72:75], v[148:151], v[124:127], v[72:75]
    ds_read_b64_tr_b16 v[114:115], v24 offset:896
    s_add_u32 m0, s10, 71808
    v_mfma_f32_16x16x32_bf16 v[76:79], v[148:151], v[128:131], v[76:79]
    ds_read_b64_tr_b16 v[116:117], v25 offset:160
    s_nop 0
    buffer_load_dwordx4 v234, s[64:67], s8 offen lds
    v_mfma_f32_16x16x32_bf16 v[80:83], v[152:155], v[124:127], v[80:83]
    ds_read_b64_tr_b16 v[118:119], v25 offset:928
    s_add_u32 m0, s10, 72832
    v_mfma_f32_16x16x32_bf16 v[84:87], v[152:155], v[128:131], v[84:87]
    ds_read_b128 v[120:123], v27 offset:0
    s_nop 0
    buffer_load_dwordx4 v235, s[64:67], s8 offen lds
    s_waitcnt lgkmcnt(0)
    v_mfma_f32_16x16x32_bf16 v[240:243], v[120:123], v[88:91], v[240:243]
    ds_read_b128 v[124:127], v20 offset:0
    s_add_u32 m0, s10, 73856
    v_mfma_f32_16x16x32_bf16 v[244:247], v[120:123], v[92:95], v[244:247]
    ds_read_b128 v[128:131], v21 offset:0
    s_nop 0
    buffer_load_dwordx4 v236, s[64:67], s8 offen lds
    v_mfma_f32_16x16x32_bf16 v[40:43], v[96:99], v[88:91], v[40:43]
    ds_read_b64_tr_b16 v[132:133], v24 offset:6144
    v_mfma_f32_16x16x32_bf16 v[44:47], v[96:99], v[92:95], v[44:47]
    ds_read_b64_tr_b16 v[134:135], v24 offset:6912
    s_add_u32 m0, s10, 74880
    v_mfma_f32_16x16x32_bf16 v[48:51], v[100:103], v[88:91], v[48:51]
    ds_read_b64_tr_b16 v[136:137], v25 offset:6176
    ds_read_b64_tr_b16 v[138:139], v25 offset:6944
    v_mfma_f32_16x16x32_bf16 v[52:55], v[100:103], v[92:95], v[52:55]
    s_nop 0
    buffer_load_dwordx4 v232, s[64:67], s9 offen lds
    v_mfma_f32_16x16x32_bf16 v[56:59], v[104:107], v[88:91], v[56:59]
    ds_read_b64_tr_b16 v[140:141], v24 offset:6208
    ds_read_b64_tr_b16 v[142:143], v24 offset:6976
    v_mfma_f32_16x16x32_bf16 v[60:63], v[104:107], v[92:95], v[60:63]
    s_add_u32 m0, s10, 75904
    ds_read_b64_tr_b16 v[144:145], v25 offset:6240
    v_mfma_f32_16x16x32_bf16 v[64:67], v[108:111], v[88:91], v[64:67]
    ds_read_b64_tr_b16 v[146:147], v25 offset:7008
    v_mfma_f32_16x16x32_bf16 v[68:71], v[108:111], v[92:95], v[68:71]
    s_nop 0
    buffer_load_dwordx4 v233, s[64:67], s9 offen lds
    ds_read_b64_tr_b16 v[148:149], v24 offset:6272
    v_mfma_f32_16x16x32_bf16 v[72:75], v[112:115], v[88:91], v[72:75]
    ds_read_b64_tr_b16 v[150:151], v24 offset:7040
    s_add_u32 m0, s10, 76928
    v_mfma_f32_16x16x32_bf16 v[76:79], v[112:115], v[92:95], v[76:79]
    ds_read_b64_tr_b16 v[152:153], v25 offset:6304
    v_mfma_f32_16x16x32_bf16 v[80:83], v[116:119], v[88:91], v[80:83]
    ds_read_b64_tr_b16 v[154:155], v25 offset:7072
    s_mov_b32 exec_hi, 0
    buffer_load_dwordx4 v234, s[64:67], s9 offen lds
    s_mov_b32 exec_hi, -1
    v_mfma_f32_16x16x32_bf16 v[84:87], v[116:119], v[92:95], v[84:87]
    ds_read_b128 v[156:159], v27 offset:64
    s_waitcnt vmcnt(10) lgkmcnt(0)
    s_barrier
    v_mfma_f32_16x16x32_bf16 v[240:243], v[156:159], v[124:127], v[240:243]
    ds_read_b128 v[88:91], v14 offset:0
    s_add_u32 s8, s47, 2
    s_and_b32 s8, s8, 3
    v_mfma_f32_16x16x32_bf16 v[244:247], v[156:159], v[128:131], v[244:247]
    ds_read_b128 v[92:95], v15 offset:0
    s_lshl2_add_u32 s8, s46, s8
    v_mfma_f32_16x16x32_bf16 v[40:43], v[132:135], v[124:127], v[40:43]
    ds_read_b64_tr_b16 v[96:97], v22 offset:0
    s_lshl2_add_u32 s8, s8, s48
    v_mfma_f32_16x16x32_bf16 v[44:47], v[132:135], v[128:131], v[44:47]
    ds_read_b64_tr_b16 v[98:99], v22 offset:768
    s_mul_i32 s8, s8, 30720
    v_mfma_f32_16x16x32_bf16 v[48:51], v[136:139], v[124:127], v[48:51]
    ds_read_b64_tr_b16 v[100:101], v23 offset:32
    s_mul_i32 s9, s47, 320
    ds_read_b64_tr_b16 v[102:103], v23 offset:800
    v_mfma_f32_16x16x32_bf16 v[52:55], v[136:139], v[128:131], v[52:55]
    s_add_u32 s8, s8, s9
    ds_read_b64_tr_b16 v[104:105], v22 offset:64
    v_mfma_f32_16x16x32_bf16 v[56:59], v[140:143], v[124:127], v[56:59]
    s_add_u32 s9, s8, 20480
    ds_read_b64_tr_b16 v[106:107], v22 offset:832
    v_mfma_f32_16x16x32_bf16 v[60:63], v[140:143], v[128:131], v[60:63]
    s_add_u32 m0, s10, 108800
    ds_read_b64_tr_b16 v[108:109], v23 offset:96
    v_mfma_f32_16x16x32_bf16 v[64:67], v[144:147], v[124:127], v[64:67]
    s_nop 0
    buffer_load_dwordx4 v232, s[64:67], s8 offen lds
    ds_read_b64_tr_b16 v[110:111], v23 offset:864
    v_mfma_f32_16x16x32_bf16 v[68:71], v[144:147], v[128:131], v[68:71]
    s_add_u32 m0, s10, 109824
    ds_read_b64_tr_b16 v[112:113], v22 offset:128
    s_nop 0
    buffer_load_dwordx4 v233, s[64:67], s8 offen lds
    v_mfma_f32_16x16x32_bf16 v[72:75], v[148:151], v[124:127], v[72:75]
    ds_read_b64_tr_b16 v[114:115], v22 offset:896
    s_add_u32 m0, s10, 110848
    v_mfma_f32_16x16x32_bf16 v[76:79], v[148:151], v[128:131], v[76:79]
    ds_read_b64_tr_b16 v[116:117], v23 offset:160
    s_nop 0
    buffer_load_dwordx4 v234, s[64:67], s8 offen lds
    v_mfma_f32_16x16x32_bf16 v[80:83], v[152:155], v[124:127], v[80:83]
    ds_read_b64_tr_b16 v[118:119], v23 offset:928
    s_add_u32 m0, s10, 111872
    v_mfma_f32_16x16x32_bf16 v[84:87], v[152:155], v[128:131], v[84:87]
    ds_read_b128 v[120:123], v26 offset:0
    s_nop 0
    buffer_load_dwordx4 v235, s[64:67], s8 offen lds
    s_waitcnt lgkmcnt(0)
    v_mfma_f32_16x16x32_bf16 v[240:243], v[120:123], v[88:91], v[240:243]
    ds_read_b128 v[124:127], v16 offset:0
    s_add_u32 m0, s10, 112896
    v_mfma_f32_16x16x32_bf16 v[244:247], v[120:123], v[92:95], v[244:247]
    ds_read_b128 v[128:131], v17 offset:0
    s_nop 0
    buffer_load_dwordx4 v236, s[64:67], s8 offen lds
    v_mfma_f32_16x16x32_bf16 v[40:43], v[96:99], v[88:91], v[40:43]
    ds_read_b64_tr_b16 v[132:133], v22 offset:6144
    v_mfma_f32_16x16x32_bf16 v[44:47], v[96:99], v[92:95], v[44:47]
    ds_read_b64_tr_b16 v[134:135], v22 offset:6912
    s_add_u32 m0, s10, 113920
    v_mfma_f32_16x16x32_bf16 v[48:51], v[100:103], v[88:91], v[48:51]
    ds_read_b64_tr_b16 v[136:137], v23 offset:6176
    ds_read_b64_tr_b16 v[138:139], v23 offset:6944
    v_mfma_f32_16x16x32_bf16 v[52:55], v[100:103], v[92:95], v[52:55]
    s_nop 0
    buffer_load_dwordx4 v232, s[64:67], s9 offen lds
    v_mfma_f32_16x16x32_bf16 v[56:59], v[104:107], v[88:91], v[56:59]
    ds_read_b64_tr_b16 v[140:141], v22 offset:6208
    ds_read_b64_tr_b16 v[142:143], v22 offset:6976
    v_mfma_f32_16x16x32_bf16 v[60:63], v[104:107], v[92:95], v[60:63]
    s_add_u32 m0, s10, 114944
    ds_read_b64_tr_b16 v[144:145], v23 offset:6240
    v_mfma_f32_16x16x32_bf16 v[64:67], v[108:111], v[88:91], v[64:67]
    ds_read_b64_tr_b16 v[146:147], v23 offset:7008
    v_mfma_f32_16x16x32_bf16 v[68:71], v[108:111], v[92:95], v[68:71]
    s_nop 0
    buffer_load_dwordx4 v233, s[64:67], s9 offen lds
    ds_read_b64_tr_b16 v[148:149], v22 offset:6272
    v_mfma_f32_16x16x32_bf16 v[72:75], v[112:115], v[88:91], v[72:75]
    ds_read_b64_tr_b16 v[150:151], v22 offset:7040
    s_add_u32 m0, s10, 115968
    v_mfma_f32_16x16x32_bf16 v[76:79], v[112:115], v[92:95], v[76:79]
    ds_read_b64_tr_b16 v[152:153], v23 offset:6304
    v_mfma_f32_16x16x32_bf16 v[80:83], v[116:119], v[88:91], v[80:83]
    ds_read_b64_tr_b16 v[154:155], v23 offset:7072
    s_mov_b32 exec_hi, 0
    buffer_load_dwordx4 v234, s[64:67], s9 offen lds
    s_mov_b32 exec_hi, -1
    v_mfma_f32_16x16x32_bf16 v[84:87], v[116:119], v[92:95], v[84:87]
    ds_read_b128 v[156:159], v26 offset:64
    s_waitcnt vmcnt(8) lgkmcnt(0)
    s_barrier
    v_mfma_f32_16x16x32_bf16 v[240:243], v[156:159], v[124:127], v[240:243]
    v_mfma_f32_16x16x32_bf16 v[244:247], v[156:159], v[128:131], v[244:247]
    v_mfma_f32_16x16x32_bf16 v[40:43], v[132:135], v[124:127], v[40:43]
    v_mfma_f32_16x16x32_bf16 v[44:47], v[132:135], v[128:131], v[44:47]
    v_mfma_f32_16x16x32_bf16 v[48:51], v[136:139], v[124:127], v[48:51]
    v_mfma_f32_16x16x32_bf16 v[52:55], v[136:139], v[128:131], v[52:55]
    v_mfma_f32_16x16x32_bf16 v[56:59], v[140:143], v[124:127], v[56:59]
    v_mfma_f32_16x16x32_bf16 v[60:63], v[140:143], v[128:131], v[60:63]
    v_mfma_f32_16x16x32_bf16 v[64:67], v[144:147], v[124:127], v[64:67]
    v_mfma_f32_16x16x32_bf16 v[68:71], v[144:147], v[128:131], v[68:71]
    v_mfma_f32_16x16x32_bf16 v[72:75], v[148:151], v[124:127], v[72:75]
    v_mul_f32 v12, 0xbfb8aa3b, v240
    v_mul_f32 v26, 0xbfb8aa3b, v244
    v_exp_f32 v12, v12
    v_exp_f32 v26, v26
    v_mfma_f32_16x16x32_bf16 v[76:79], v[148:151], v[128:131], v[76:79]
    v_add_f32 v12, 1.0, v12
    v_add_f32 v26, 1.0, v26
    v_rcp_f32 v12, v12
    v_rcp_f32 v26, v26
    v_mfma_f32_16x16x32_bf16 v[80:83], v[152:155], v[124:127], v[80:83]
    v_xor_b32 v13, 64, v11
    ds_write_b32 v11, v12
    ds_write_b32 v13, v26
    v_mov_b32 v39, 1
    v_mfma_f32_16x16x32_bf16 v[84:87], v[152:155], v[128:131], v[84:87]
    ds_write_b32 v29, v39
    v_sub_f32 v12, 1.0, v12
    v_sub_f32 v26, 1.0, v26
    s_setprio 2
    s_mul_i32 s50, s45, 3072
    s_add_u32 s50, s50, s13
    s_add_u32 s51, s50, s16
    v_mov_b64 v[14:15], v[248:249]
    v_mov_b64 v[16:17], v[250:251]
    v_mov_b64 v[18:19], v[252:253]
    v_mov_b64 v[20:21], v[254:255]
    v_pk_mul_f32 v[88:89], v[40:41], v[12:13] op_sel_hi:[1,0]
    v_pk_mul_f32 v[90:91], v[42:43], v[12:13] op_sel_hi:[1,0]
    v_pk_mul_f32 v[92:93], v[48:49], v[12:13] op_sel_hi:[1,0]
    v_pk_mul_f32 v[94:95], v[50:51], v[12:13] op_sel_hi:[1,0]
    v_max_f32 v40, 0, v40
    v_max_f32 v41, 0, v41
    v_max_f32 v42, 0, v42
    v_max_f32 v43, 0, v43
    v_max_f32 v48, 0, v48
    v_max_f32 v49, 0, v49
    v_max_f32 v50, 0, v50
    v_max_f32 v51, 0, v51
    v_pk_mul_f32 v[40:41], v[40:41], v[88:89]
    v_pk_mul_f32 v[42:43], v[42:43], v[90:91]
    v_pk_mul_f32 v[48:49], v[48:49], v[92:93]
    v_pk_mul_f32 v[50:51], v[50:51], v[94:95]
    v_cvt_pk_bf16_f32 v120, v40, v41
    v_cvt_pk_bf16_f32 v121, v42, v43
    v_cvt_pk_bf16_f32 v122, v48, v49
    v_cvt_pk_bf16_f32 v123, v50, v51
    buffer_store_dwordx4 v[120:123], v2, s[40:43], s50 offen offset:0 sc1
    v_pk_mul_f32 v[88:89], v[44:45], v[26:27] op_sel_hi:[1,0]
    v_pk_mul_f32 v[90:91], v[46:47], v[26:27] op_sel_hi:[1,0]
    v_pk_mul_f32 v[92:93], v[52:53], v[26:27] op_sel_hi:[1,0]
    v_pk_mul_f32 v[94:95], v[54:55], v[26:27] op_sel_hi:[1,0]
    v_max_f32 v44, 0, v44
    v_max_f32 v45, 0, v45
    v_max_f32 v46, 0, v46
    v_max_f32 v47, 0, v47
    v_max_f32 v52, 0, v52
    v_max_f32 v53, 0, v53
    v_max_f32 v54, 0, v54
    v_max_f32 v55, 0, v55
    v_pk_mul_f32 v[44:45], v[44:45], v[88:89]
    v_pk_mul_f32 v[46:47], v[46:47], v[90:91]
    v_pk_mul_f32 v[52:53], v[52:53], v[92:93]
    v_pk_mul_f32 v[54:55], v[54:55], v[94:95]
    v_cvt_pk_bf16_f32 v124, v44, v45
    v_cvt_pk_bf16_f32 v125, v46, v47
    v_cvt_pk_bf16_f32 v126, v52, v53
    v_cvt_pk_bf16_f32 v127, v54, v55
    buffer_store_dwordx4 v[124:127], v2, s[40:43], s51 offen offset:0 sc1
    v_pk_mul_f32 v[88:89], v[56:57], v[12:13] op_sel_hi:[1,0]
    v_pk_mul_f32 v[90:91], v[58:59], v[12:13] op_sel_hi:[1,0]
    v_pk_mul_f32 v[92:93], v[64:65], v[12:13] op_sel_hi:[1,0]
    v_pk_mul_f32 v[94:95], v[66:67], v[12:13] op_sel_hi:[1,0]
    v_max_f32 v56, 0, v56
    v_max_f32 v57, 0, v57
    v_max_f32 v58, 0, v58
    v_max_f32 v59, 0, v59
    v_max_f32 v64, 0, v64
    v_max_f32 v65, 0, v65
    v_max_f32 v66, 0, v66
    v_max_f32 v67, 0, v67
    v_pk_mul_f32 v[56:57], v[56:57], v[88:89]
    v_pk_mul_f32 v[58:59], v[58:59], v[90:91]
    v_pk_mul_f32 v[64:65], v[64:65], v[92:93]
    v_pk_mul_f32 v[66:67], v[66:67], v[94:95]
    v_cvt_pk_bf16_f32 v128, v56, v57
    v_cvt_pk_bf16_f32 v129, v58, v59
    v_cvt_pk_bf16_f32 v130, v64, v65
    v_cvt_pk_bf16_f32 v131, v66, v67
    buffer_store_dwordx4 v[128:131], v2, s[40:43], s50 offen offset:1024 sc1
    v_pk_mul_f32 v[88:89], v[60:61], v[26:27] op_sel_hi:[1,0]
    v_pk_mul_f32 v[90:91], v[62:63], v[26:27] op_sel_hi:[1,0]
    v_pk_mul_f32 v[92:93], v[68:69], v[26:27] op_sel_hi:[1,0]
    v_pk_mul_f32 v[94:95], v[70:71], v[26:27] op_sel_hi:[1,0]
    v_max_f32 v60, 0, v60
    v_max_f32 v61, 0, v61
    v_max_f32 v62, 0, v62
    v_max_f32 v63, 0, v63
    v_max_f32 v68, 0, v68
    v_max_f32 v69, 0, v69
    v_max_f32 v70, 0, v70
    v_max_f32 v71, 0, v71
    v_pk_mul_f32 v[60:61], v[60:61], v[88:89]
    v_pk_mul_f32 v[62:63], v[62:63], v[90:91]
    v_pk_mul_f32 v[68:69], v[68:69], v[92:93]
    v_pk_mul_f32 v[70:71], v[70:71], v[94:95]
    v_cvt_pk_bf16_f32 v132, v60, v61
    v_cvt_pk_bf16_f32 v133, v62, v63
    v_cvt_pk_bf16_f32 v134, v68, v69
    v_cvt_pk_bf16_f32 v135, v70, v71
    buffer_store_dwordx4 v[132:135], v2, s[40:43], s51 offen offset:1024 sc1
    v_pk_mul_f32 v[88:89], v[72:73], v[12:13] op_sel_hi:[1,0]
    v_pk_mul_f32 v[90:91], v[74:75], v[12:13] op_sel_hi:[1,0]
    v_pk_mul_f32 v[92:93], v[80:81], v[12:13] op_sel_hi:[1,0]
    v_pk_mul_f32 v[94:95], v[82:83], v[12:13] op_sel_hi:[1,0]
    v_max_f32 v72, 0, v72
    v_max_f32 v73, 0, v73
    v_max_f32 v74, 0, v74
    v_max_f32 v75, 0, v75
    v_max_f32 v80, 0, v80
    v_max_f32 v81, 0, v81
    v_max_f32 v82, 0, v82
    v_max_f32 v83, 0, v83
    v_pk_mul_f32 v[72:73], v[72:73], v[88:89]
    v_pk_mul_f32 v[74:75], v[74:75], v[90:91]
    v_pk_mul_f32 v[80:81], v[80:81], v[92:93]
    v_pk_mul_f32 v[82:83], v[82:83], v[94:95]
    v_cvt_pk_bf16_f32 v136, v72, v73
    v_cvt_pk_bf16_f32 v137, v74, v75
    v_cvt_pk_bf16_f32 v138, v80, v81
    v_cvt_pk_bf16_f32 v139, v82, v83
    buffer_store_dwordx4 v[136:139], v2, s[40:43], s50 offen offset:2048 sc1
    v_pk_mul_f32 v[88:89], v[76:77], v[26:27] op_sel_hi:[1,0]
    v_pk_mul_f32 v[90:91], v[78:79], v[26:27] op_sel_hi:[1,0]
    v_pk_mul_f32 v[92:93], v[84:85], v[26:27] op_sel_hi:[1,0]
    v_pk_mul_f32 v[94:95], v[86:87], v[26:27] op_sel_hi:[1,0]
    v_max_f32 v76, 0, v76
    v_max_f32 v77, 0, v77
    v_max_f32 v78, 0, v78
    v_max_f32 v79, 0, v79
    v_max_f32 v84, 0, v84
    v_max_f32 v85, 0, v85
    v_max_f32 v86, 0, v86
    v_max_f32 v87, 0, v87
    v_pk_mul_f32 v[76:77], v[76:77], v[88:89]
    v_pk_mul_f32 v[78:79], v[78:79], v[90:91]
    v_pk_mul_f32 v[84:85], v[84:85], v[92:93]
    v_pk_mul_f32 v[86:87], v[86:87], v[94:95]
    v_cvt_pk_bf16_f32 v140, v76, v77
    v_cvt_pk_bf16_f32 v141, v78, v79
    v_cvt_pk_bf16_f32 v142, v84, v85
    v_cvt_pk_bf16_f32 v143, v86, v87
    buffer_store_dwordx4 v[140:143], v2, s[40:43], s51 offen offset:2048 sc1
    s_setprio 0
    v_mov_b32 v27, 156832
    ds_read_b64_tr_b16 v[200:201], v14 offset:0
    ds_read_b64_tr_b16 v[202:203], v14 offset:5120
    ds_read_b64_tr_b16 v[204:205], v15 offset:0
    ds_read_b64_tr_b16 v[206:207], v15 offset:5120
    ds_read_b64_tr_b16 v[208:209], v14 offset:64
    ds_read_b64_tr_b16 v[210:211], v14 offset:5184
    ds_read_b64_tr_b16 v[212:213], v15 offset:64
    ds_read_b64_tr_b16 v[214:215], v15 offset:5184
    ds_read_b64_tr_b16 v[216:217], v14 offset:128
    ds_read_b64_tr_b16 v[218:219], v14 offset:5248
    s_waitcnt lgkmcnt(8)
    v_mfma_f32_16x16x32_bf16 v[40:43], v[200:203], v[120:123], 0
    ds_read_b64_tr_b16 v[220:221], v16 offset:0
    ds_read_b64_tr_b16 v[222:223], v16 offset:5120
    v_mfma_f32_16x16x32_bf16 v[80:83], v[200:203], v[124:127], 0
    s_waitcnt lgkmcnt(8)
    v_mfma_f32_16x16x32_bf16 v[44:47], v[204:207], v[120:123], 0
    ds_read_b64_tr_b16 v[200:201], v17 offset:0
    ds_read_b64_tr_b16 v[202:203], v17 offset:5120
    v_mfma_f32_16x16x32_bf16 v[84:87], v[204:207], v[124:127], 0
    s_waitcnt lgkmcnt(8)
    v_mfma_f32_16x16x32_bf16 v[48:51], v[208:211], v[120:123], 0
    ds_read_b64_tr_b16 v[204:205], v16 offset:64
    ds_read_b64_tr_b16 v[206:207], v16 offset:5184
    v_mfma_f32_16x16x32_bf16 v[88:91], v[208:211], v[124:127], 0
    s_waitcnt lgkmcnt(8)
    v_mfma_f32_16x16x32_bf16 v[52:55], v[212:215], v[120:123], 0
    ds_read_b64_tr_b16 v[208:209], v17 offset:64
    ds_read_b64_tr_b16 v[210:211], v17 offset:5184
    v_mfma_f32_16x16x32_bf16 v[92:95], v[212:215], v[124:127], 0
    s_waitcnt lgkmcnt(8)
    v_mfma_f32_16x16x32_bf16 v[56:59], v[216:219], v[120:123], 0
    ds_read_b64_tr_b16 v[212:213], v16 offset:128
    ds_read_b64_tr_b16 v[214:215], v16 offset:5248
    v_mfma_f32_16x16x32_bf16 v[96:99], v[216:219], v[124:127], 0
    s_waitcnt lgkmcnt(8)
    v_mfma_f32_16x16x32_bf16 v[60:63], v[220:223], v[120:123], 0
    ds_read_b64_tr_b16 v[216:217], v14 offset:10240
    ds_read_b64_tr_b16 v[218:219], v14 offset:15360
    v_mfma_f32_16x16x32_bf16 v[100:103], v[220:223], v[124:127], 0
    s_waitcnt lgkmcnt(8)
    v_mfma_f32_16x16x32_bf16 v[64:67], v[200:203], v[120:123], 0
    ds_read_b64_tr_b16 v[220:221], v15 offset:10240
    ds_read_b64_tr_b16 v[222:223], v15 offset:15360
    v_mfma_f32_16x16x32_bf16 v[104:107], v[200:203], v[124:127], 0
    s_waitcnt lgkmcnt(8)
    v_mfma_f32_16x16x32_bf16 v[68:71], v[204:207], v[120:123], 0
    ds_read_b64_tr_b16 v[200:201], v14 offset:10304
    ds_read_b64_tr_b16 v[202:203], v14 offset:15424
    v_mfma_f32_16x16x32_bf16 v[108:111], v[204:207], v[124:127], 0
    s_waitcnt lgkmcnt(8)
    v_mfma_f32_16x16x32_bf16 v[72:75], v[208:211], v[120:123], 0
    ds_read_b64_tr_b16 v[204:205], v15 offset:10304
    ds_read_b64_tr_b16 v[206:207], v15 offset:15424
    v_mfma_f32_16x16x32_bf16 v[112:115], v[208:211], v[124:127], 0
    s_waitcnt lgkmcnt(8)
    v_mfma_f32_16x16x32_bf16 v[76:79], v[212:215], v[120:123], 0
    ds_read_b64_tr_b16 v[208:209], v14 offset:10368
    ds_read_b64_tr_b16 v[210:211], v14 offset:15488
    v_mfma_f32_16x16x32_bf16 v[116:119], v[212:215], v[124:127], 0
    s_waitcnt lgkmcnt(8)
    v_mfma_f32_16x16x32_bf16 v[40:43], v[216:219], v[128:131], v[40:43]
    ds_read_b64_tr_b16 v[212:213], v16 offset:10240
    ds_read_b64_tr_b16 v[214:215], v16 offset:15360
    v_mfma_f32_16x16x32_bf16 v[80:83], v[216:219], v[132:135], v[80:83]
    s_waitcnt lgkmcnt(8)
    v_mfma_f32_16x16x32_bf16 v[44:47], v[220:223], v[128:131], v[44:47]
    ds_read_b64_tr_b16 v[216:217], v17 offset:10240
    ds_read_b64_tr_b16 v[218:219], v17 offset:15360
    v_mfma_f32_16x16x32_bf16 v[84:87], v[220:223], v[132:135], v[84:87]
    s_waitcnt lgkmcnt(8)
    v_mfma_f32_16x16x32_bf16 v[48:51], v[200:203], v[128:131], v[48:51]
    ds_read_b64_tr_b16 v[220:221], v16 offset:10304
    ds_read_b64_tr_b16 v[222:223], v16 offset:15424
    v_mfma_f32_16x16x32_bf16 v[88:91], v[200:203], v[132:135], v[88:91]
    s_waitcnt lgkmcnt(8)
    v_mfma_f32_16x16x32_bf16 v[52:55], v[204:207], v[128:131], v[52:55]
    ds_read_b64_tr_b16 v[200:201], v17 offset:10304
    ds_read_b64_tr_b16 v[202:203], v17 offset:15424
    v_mfma_f32_16x16x32_bf16 v[92:95], v[204:207], v[132:135], v[92:95]
    s_waitcnt lgkmcnt(8)
    v_mfma_f32_16x16x32_bf16 v[56:59], v[208:211], v[128:131], v[56:59]
    ds_read_b64_tr_b16 v[204:205], v16 offset:10368
    ds_read_b64_tr_b16 v[206:207], v16 offset:15488
    v_mfma_f32_16x16x32_bf16 v[96:99], v[208:211], v[132:135], v[96:99]
    s_waitcnt lgkmcnt(8)
    v_mfma_f32_16x16x32_bf16 v[60:63], v[212:215], v[128:131], v[60:63]
    ds_read_b64_tr_b16 v[208:209], v14 offset:20480
    ds_read_b64_tr_b16 v[210:211], v14 offset:25600
    v_mfma_f32_16x16x32_bf16 v[100:103], v[212:215], v[132:135], v[100:103]
    s_waitcnt lgkmcnt(8)
    v_mfma_f32_16x16x32_bf16 v[64:67], v[216:219], v[128:131], v[64:67]
    ds_read_b64_tr_b16 v[212:213], v15 offset:20480
    ds_read_b64_tr_b16 v[214:215], v15 offset:25600
    v_mfma_f32_16x16x32_bf16 v[104:107], v[216:219], v[132:135], v[104:107]
    s_waitcnt lgkmcnt(8)
    v_mfma_f32_16x16x32_bf16 v[68:71], v[220:223], v[128:131], v[68:71]
    ds_read_b64_tr_b16 v[216:217], v14 offset:20544
    ds_read_b64_tr_b16 v[218:219], v14 offset:25664
    v_mfma_f32_16x16x32_bf16 v[108:111], v[220:223], v[132:135], v[108:111]
    s_waitcnt lgkmcnt(8)
    v_mfma_f32_16x16x32_bf16 v[72:75], v[200:203], v[128:131], v[72:75]
    ds_read_b64_tr_b16 v[220:221], v15 offset:20544
    ds_read_b64_tr_b16 v[222:223], v15 offset:25664
    v_mfma_f32_16x16x32_bf16 v[112:115], v[200:203], v[132:135], v[112:115]
    s_waitcnt lgkmcnt(8)
    v_mfma_f32_16x16x32_bf16 v[76:79], v[204:207], v[128:131], v[76:79]
    ds_read_b64_tr_b16 v[200:201], v14 offset:20608
    ds_read_b64_tr_b16 v[202:203], v14 offset:25728
    v_mfma_f32_16x16x32_bf16 v[116:119], v[204:207], v[132:135], v[116:119]
    s_lshl4_add_u32 s50, s44, s45
    s_lshl_b32 s50, s50, 5
    s_add_u32 s50, s50, s48
    s_lshl_b32 s50, s50, 7
    s_add_u32 s50, s50, 0x100300
    v_mov_b32 v38, s49
    s_waitcnt vmcnt(0)
    s_mov_b64 exec, 1
    buffer_store_dword v38, off, s[40:43], s50 sc1
    s_mov_b64 exec, -1
    s_waitcnt lgkmcnt(8)
    v_mfma_f32_16x16x32_bf16 v[40:43], v[208:211], v[136:139], v[40:43]
    ds_read_b64_tr_b16 v[204:205], v16 offset:20480
    ds_read_b64_tr_b16 v[206:207], v16 offset:25600
    v_mfma_f32_16x16x32_bf16 v[80:83], v[208:211], v[140:143], v[80:83]
    s_waitcnt lgkmcnt(8)
    v_mfma_f32_16x16x32_bf16 v[44:47], v[212:215], v[136:139], v[44:47]
    ds_read_b64_tr_b16 v[208:209], v17 offset:20480
    ds_read_b64_tr_b16 v[210:211], v17 offset:25600
    v_mfma_f32_16x16x32_bf16 v[84:87], v[212:215], v[140:143], v[84:87]
    s_waitcnt lgkmcnt(8)
    v_mfma_f32_16x16x32_bf16 v[48:51], v[216:219], v[136:139], v[48:51]
    ds_read_b64_tr_b16 v[212:213], v16 offset:20544
    ds_read_b64_tr_b16 v[214:215], v16 offset:25664
    v_mfma_f32_16x16x32_bf16 v[88:91], v[216:219], v[140:143], v[88:91]
    s_waitcnt lgkmcnt(8)
    v_mfma_f32_16x16x32_bf16 v[52:55], v[220:223], v[136:139], v[52:55]
    ds_read_b64_tr_b16 v[216:217], v17 offset:20544
    ds_read_b64_tr_b16 v[218:219], v17 offset:25664
    v_mfma_f32_16x16x32_bf16 v[92:95], v[220:223], v[140:143], v[92:95]
    s_waitcnt lgkmcnt(8)
    v_mfma_f32_16x16x32_bf16 v[56:59], v[200:203], v[136:139], v[56:59]
    ds_read_b64_tr_b16 v[220:221], v16 offset:20608
    ds_read_b64_tr_b16 v[222:223], v16 offset:25728
    v_mfma_f32_16x16x32_bf16 v[96:99], v[200:203], v[140:143], v[96:99]
    s_waitcnt lgkmcnt(8)
    v_mfma_f32_16x16x32_bf16 v[60:63], v[204:207], v[136:139], v[60:63]
    ds_read_b64_tr_b16 v[200:201], v18 offset:0
    ds_read_b64_tr_b16 v[202:203], v18 offset:5120
    v_mfma_f32_16x16x32_bf16 v[100:103], v[204:207], v[140:143], v[100:103]
    s_waitcnt lgkmcnt(8)
    v_mfma_f32_16x16x32_bf16 v[64:67], v[208:211], v[136:139], v[64:67]
    ds_read_b64_tr_b16 v[204:205], v19 offset:0
    ds_read_b64_tr_b16 v[206:207], v19 offset:5120
    v_mfma_f32_16x16x32_bf16 v[104:107], v[208:211], v[140:143], v[104:107]
    s_waitcnt lgkmcnt(8)
    v_mfma_f32_16x16x32_bf16 v[68:71], v[212:215], v[136:139], v[68:71]
    ds_read_b64_tr_b16 v[208:209], v18 offset:64
    ds_read_b64_tr_b16 v[210:211], v18 offset:5184
    v_mfma_f32_16x16x32_bf16 v[108:111], v[212:215], v[140:143], v[108:111]
    s_waitcnt lgkmcnt(8)
    v_mfma_f32_16x16x32_bf16 v[72:75], v[216:219], v[136:139], v[72:75]
    ds_read_b64_tr_b16 v[212:213], v19 offset:64
    ds_read_b64_tr_b16 v[214:215], v19 offset:5184
    v_mfma_f32_16x16x32_bf16 v[112:115], v[216:219], v[140:143], v[112:115]
    s_waitcnt lgkmcnt(8)
    v_mfma_f32_16x16x32_bf16 v[76:79], v[220:223], v[136:139], v[76:79]
    ds_read_b64_tr_b16 v[216:217], v18 offset:128
    ds_read_b64_tr_b16 v[218:219], v18 offset:5248
    v_mfma_f32_16x16x32_bf16 v[116:119], v[220:223], v[140:143], v[116:119]
    v_mul_u32_u24 v4, 205, v1
    v_lshrrev_b32 v4, 12, v4
    v_mul_u32_u24 v5, 20, v4
    v_sub_u32 v5, v1, v5
    s_and_b32 s50, s46, 1
    s_lshl1_add_u32 s50, s47, s50
    s_mul_i32 s50, s50, 160
    v_lshl_add_u32 v6, v5, 3, s50
    s_lshr_b32 s17, s46, 1
    s_lshl1_add_u32 s17, s48, s17
    s_lshl3_add_u32 s52, s44, s17
    s_mul_i32 s68, s52, 20480
    s_mul_i32 s69, s52, 40960
    v_mul_u32_u24 v7, 1280, v4
    v_add_u32 v7, v7, v6
    v_mov_b32 v12, v7
    v_mov_b32 v13, v6
    v_mov_b32 v37, 0xffff0000
    v_bfe_u32 v11, v1, 4, 1
    v_mul_u32_u24 v36, 10240, v11
    v_lshrrev_b32 v38, 5, v1
    v_bfe_u32 v24, v1, 1, 3
    v_xor_b32 v24, v38, v24
    v_lshlrev_b32 v24, 4, v24
    v_lshl_add_u32 v24, v36, 1, v24
    v_and_b32 v39, 15, v1
    v_lshl_add_u32 v24, v39, 7, v24
    v_add_u32 v24, 69760, v24
    v_bfe_u32 v22, v1, 2, 2
    v_xor_b32 v22, v38, v22
    v_lshl_add_u32 v22, v22, 4, v36
    v_lshl_add_u32 v22, v39, 6, v22
    v_xor_b32 v23, 32, v22
    s_lshl2_add_u32 s22, s44, s47
    s_lshl_b32 s32, s22, 6
    s_add_u32 s32, s32, s48
    s_mul_i32 s32, s32, 2560
    s_add_u32 s32, s32, 0x1400000
    s_mul_i32 s33, s46, 40960
    s_add_u32 s33, s33, s32
    s_lshl4_add_u32 s22, s44, s47
    s_lshl_b32 s22, s22, 5
    s_add_u32 s22, s22, s48
    s_lshl_b32 s22, s22, 7
    s_add_u32 s22, s22, 0x100700
    v_lshlrev_b32 v8, 3, v1
    s_mov_b32 s60, s34
    s_mov_b32 s61, s35
    s_mov_b32 s62, 0x500000
    s_mov_b32 s63, 0x20000
    s_mul_i32 s50, s48, 39040
    s_add_u32 s50, s50, 61440
    s_cmp_eq_u32 s48, 3
    s_cselect_b32 s50, 147840, s50
    v_mul_u32_u24 v9, 336, v39
    v_lshrrev_b32 v38, 4, v1
    v_lshl_add_u32 v9, v38, 4, v9
    v_add_u32 v9, s50, v9
    v_mul_u32_u24 v10, 336, v4
    v_lshl_add_u32 v10, v5, 4, v10
    v_add_u32 v10, s50, v10
    v_mul_u32_u24 v7, 2560, v4
    v_lshl_add_u32 v7, v6, 1, v7
    v_cmp_gt_u32 vcc, 60, v1
    v_mov_b32 v6, 0x80000000
    s_nop 0
    v_cndmask_b32 v7, v6, v7, vcc
    v_cmp_gt_u32 vcc, 20, v1
    s_nop 1
    v_cndmask_b32 v6, v6, v7, vcc
    s_mov_b64 exec, 15
    buffer_load_dword v30, v28, s[40:43], 0 offen sc1
    s_mov_b64 exec, -1
    s_waitcnt vmcnt(0)
    v_mov_b32 v39, 5
    ds_write_b32 v29, v39
    s_add_u32 s19, s47, 1
    s_and_b32 s19, s19, 3
    s_lshl_b32 s19, 1, s19
    v_cmp_ne_u32 vcc, s49, v30
    s_nop 1
    s_and_b32 s53, vcc_lo, s19
    s_cbranch_scc1 L_slow_1
L_ok_2:
    s_add_u32 s11, s47, 1
    s_and_b32 s11, s11, 3
    s_lshl2_add_u32 s11, s46, s11
    s_mul_i32 s11, s11, 3072
    s_add_u32 s11, s11, s13
    s_add_u32 s12, s11, s16
    buffer_load_dwordx4 v[144:147], v2, s[40:43], s11 offen offset:0 sc1
    buffer_load_dwordx4 v[148:151], v2, s[40:43], s12 offen offset:0 sc1
    buffer_load_dwordx4 v[152:155], v2, s[40:43], s11 offen offset:1024 sc1
    buffer_load_dwordx4 v[156:159], v2, s[40:43], s12 offen offset:1024 sc1
    buffer_load_dwordx4 v[160:163], v2, s[40:43], s11 offen offset:2048 sc1
    buffer_load_dwordx4 v[164:167], v2, s[40:43], s12 offen offset:2048 sc1
    s_add_u32 s19, s47, 2
    s_and_b32 s19, s19, 3
    s_lshl_b32 s19, 1, s19
    v_cmp_ne_u32 vcc, s49, v30
    s_nop 1
    s_and_b32 s53, vcc_lo, s19
    s_cbranch_scc1 L_slow_4
L_ok_5:
    s_add_u32 s11, s47, 2
    s_and_b32 s11, s11, 3
    s_lshl2_add_u32 s11, s46, s11
    s_mul_i32 s11, s11, 3072
    s_add_u32 s11, s11, s13
    s_add_u32 s12, s11, s16
    buffer_load_dwordx4 v[168:171], v2, s[40:43], s11 offen offset:0 sc1
    buffer_load_dwordx4 v[172:175], v2, s[40:43], s12 offen offset:0 sc1
    buffer_load_dwordx4 v[176:179], v2, s[40:43], s11 offen offset:1024 sc1
    buffer_load_dwordx4 v[180:183], v2, s[40:43], s12 offen offset:1024 sc1
    buffer_load_dwordx4 v[120:123], v2, s[40:43], s11 offen offset:2048 sc1
    buffer_load_dwordx4 v[124:127], v2, s[40:43], s12 offen offset:2048 sc1
    s_waitcnt vmcnt(10)
    s_waitcnt lgkmcnt(9)
    v_mfma_f32_16x16x32_bf16 v[40:43], v[200:203], v[144:147], v[40:43]
    ds_read_b64_tr_b16 v[220:221], v20 offset:0
    ds_read_b64_tr_b16 v[222:223], v20 offset:5120
    v_mfma_f32_16x16x32_bf16 v[80:83], v[200:203], v[148:151], v[80:83]
    s_mov_b64 exec, 15
    buffer_load_dword v30, v28, s[40:43], 0 offen sc1
    s_mov_b64 exec, -1
    s_waitcnt lgkmcnt(9)
    v_mfma_f32_16x16x32_bf16 v[44:47], v[204:207], v[144:147], v[44:47]
    ds_read_b64_tr_b16 v[200:201], v21 offset:0
    ds_read_b64_tr_b16 v[202:203], v21 offset:5120
    v_mfma_f32_16x16x32_bf16 v[84:87], v[204:207], v[148:151], v[84:87]
    s_waitcnt lgkmcnt(9)
    v_mfma_f32_16x16x32_bf16 v[48:51], v[208:211], v[144:147], v[48:51]
    ds_read_b64_tr_b16 v[204:205], v20 offset:64
    ds_read_b64_tr_b16 v[206:207], v20 offset:5184
    v_mfma_f32_16x16x32_bf16 v[88:91], v[208:211], v[148:151], v[88:91]
    s_waitcnt lgkmcnt(9)
    v_mfma_f32_16x16x32_bf16 v[52:55], v[212:215], v[144:147], v[52:55]
    ds_read_b64_tr_b16 v[208:209], v21 offset:64
    ds_read_b64_tr_b16 v[210:211], v21 offset:5184
    v_mfma_f32_16x16x32_bf16 v[92:95], v[212:215], v[148:151], v[92:95]
    s_waitcnt lgkmcnt(9)
    v_mfma_f32_16x16x32_bf16 v[56:59], v[216:219], v[144:147], v[56:59]
    ds_read_b64_tr_b16 v[212:213], v20 offset:128
    ds_read_b64_tr_b16 v[214:215], v20 offset:5248
    v_mfma_f32_16x16x32_bf16 v[96:99], v[216:219], v[148:151], v[96:99]
    s_waitcnt lgkmcnt(8)
    v_mfma_f32_16x16x32_bf16 v[60:63], v[220:223], v[144:147], v[60:63]
    ds_read_b64_tr_b16 v[216:217], v18 offset:10240
    ds_read_b64_tr_b16 v[218:219], v18 offset:15360
    v_mfma_f32_16x16x32_bf16 v[100:103], v[220:223], v[148:151], v[100:103]
    s_waitcnt lgkmcnt(8)
    v_mfma_f32_16x16x32_bf16 v[64:67], v[200:203], v[144:147], v[64:67]
    ds_read_b64_tr_b16 v[220:221], v19 offset:10240
    ds_read_b64_tr_b16 v[222:223], v19 offset:15360
    v_mfma_f32_16x16x32_bf16 v[104:107], v[200:203], v[148:151], v[104:107]
    s_waitcnt lgkmcnt(8)
    v_mfma_f32_16x16x32_bf16 v[68:71], v[204:207], v[144:147], v[68:71]
    ds_read_b64_tr_b16 v[200:201], v18 offset:10304
    ds_read_b64_tr_b16 v[202:203], v18 offset:15424
    v_mfma_f32_16x16x32_bf16 v[108:111], v[204:207], v[148:151], v[108:111]
    s_waitcnt lgkmcnt(8)
    v_mfma_f32_16x16x32_bf16 v[72:75], v[208:211], v[144:147], v[72:75]
    ds_read_b64_tr_b16 v[204:205], v19 offset:10304
    ds_read_b64_tr_b16 v[206:207], v19 offset:15424
    v_mfma_f32_16x16x32_bf16 v[112:115], v[208:211], v[148:151], v[112:115]
    s_waitcnt lgkmcnt(8)
    v_mfma_f32_16x16x32_bf16 v[76:79], v[212:215], v[144:147], v[76:79]
    ds_read_b64_tr_b16 v[208:209], v18 offset:10368
    ds_read_b64_tr_b16 v[210:211], v18 offset:15488
    v_mfma_f32_16x16x32_bf16 v[116:119], v[212:215], v[148:151], v[116:119]
    s_waitcnt vmcnt(9)
    v_mov_b32 v39, 6
    ds_write_b32 v29, v39
    s_waitcnt lgkmcnt(9)
    v_mfma_f32_16x16x32_bf16 v[40:43], v[216:219], v[152:155], v[40:43]
    ds_read_b64_tr_b16 v[212:213], v20 offset:10240
    ds_read_b64_tr_b16 v[214:215], v20 offset:15360
    v_mfma_f32_16x16x32_bf16 v[80:83], v[216:219], v[156:159], v[80:83]
    s_waitcnt lgkmcnt(9)
    v_mfma_f32_16x16x32_bf16 v[44:47], v[220:223], v[152:155], v[44:47]
    ds_read_b64_tr_b16 v[216:217], v21 offset:10240
    ds_read_b64_tr_b16 v[218:219], v21 offset:15360
    v_mfma_f32_16x16x32_bf16 v[84:87], v[220:223], v[156:159], v[84:87]
    s_waitcnt lgkmcnt(9)
    v_mfma_f32_16x16x32_bf16 v[48:51], v[200:203], v[152:155], v[48:51]
    ds_read_b64_tr_b16 v[220:221], v20 offset:10304
    ds_read_b64_tr_b16 v[222:223], v20 offset:15424
    v_mfma_f32_16x16x32_bf16 v[88:91], v[200:203], v[156:159], v[88:91]
    s_waitcnt lgkmcnt(9)
    v_mfma_f32_16x16x32_bf16 v[52:55], v[204:207], v[152:155], v[52:55]
    ds_read_b64_tr_b16 v[200:201], v21 offset:10304
    ds_read_b64_tr_b16 v[202:203], v21 offset:15424
    v_mfma_f32_16x16x32_bf16 v[92:95], v[204:207], v[156:159], v[92:95]
    s_waitcnt lgkmcnt(9)
    v_mfma_f32_16x16x32_bf16 v[56:59], v[208:211], v[152:155], v[56:59]
    ds_read_b64_tr_b16 v[204:205], v20 offset:10368
    ds_read_b64_tr_b16 v[206:207], v20 offset:15488
    v_mfma_f32_16x16x32_bf16 v[96:99], v[208:211], v[156:159], v[96:99]
    s_waitcnt lgkmcnt(8)
    v_mfma_f32_16x16x32_bf16 v[60:63], v[212:215], v[152:155], v[60:63]
    ds_read_b64_tr_b16 v[208:209], v18 offset:20480
    ds_read_b64_tr_b16 v[210:211], v18 offset:25600
    v_mfma_f32_16x16x32_bf16 v[100:103], v[212:215], v[156:159], v[100:103]
    ds_read_b128 v[32:35], v27 offset:16
    s_waitcnt lgkmcnt(9)
    v_mfma_f32_16x16x32_bf16 v[64:67], v[216:219], v[152:155], v[64:67]
    ds_read_b64_tr_b16 v[212:213], v19 offset:20480
    ds_read_b64_tr_b16 v[214:215], v19 offset:25600
    v_mfma_f32_16x16x32_bf16 v[104:107], v[216:219], v[156:159], v[104:107]
    s_waitcnt lgkmcnt(9)
    v_mfma_f32_16x16x32_bf16 v[68:71], v[220:223], v[152:155], v[68:71]
    ds_read_b64_tr_b16 v[216:217], v18 offset:20544
    ds_read_b64_tr_b16 v[218:219], v18 offset:25664
    v_mfma_f32_16x16x32_bf16 v[108:111], v[220:223], v[156:159], v[108:111]
    s_waitcnt lgkmcnt(9)
    v_mfma_f32_16x16x32_bf16 v[72:75], v[200:203], v[152:155], v[72:75]
    ds_read_b64_tr_b16 v[220:221], v19 offset:20544
    ds_read_b64_tr_b16 v[222:223], v19 offset:25664
    v_mfma_f32_16x16x32_bf16 v[112:115], v[200:203], v[156:159], v[112:115]
    s_waitcnt lgkmcnt(9)
    v_mfma_f32_16x16x32_bf16 v[76:79], v[204:207], v[152:155], v[76:79]
    ds_read_b64_tr_b16 v[200:201], v18 offset:20608
    ds_read_b64_tr_b16 v[202:203], v18 offset:25728
    v_mfma_f32_16x16x32_bf16 v[116:119], v[204:207], v[156:159], v[116:119]
    s_waitcnt vmcnt(7)
    v_min3_u32 v32, v32, v33, v34
    v_min_u32 v32, v32, v35
    v_cmp_gt_u32 vcc, 5, v32
    s_nop 1
    s_cmp_lg_u64 vcc, 0
    s_cbranch_scc1 L_gslow_7
L_gok_8:
    s_waitcnt vmcnt(0)
    s_add_u32 s19, s47, 3
    s_and_b32 s19, s19, 3
    s_lshl_b32 s19, 1, s19
    v_cmp_ne_u32 vcc, s49, v30
    s_nop 1
    s_and_b32 s53, vcc_lo, s19
    s_cbranch_scc1 L_slow_10
L_ok_11:
    s_waitcnt lgkmcnt(9)
    v_mfma_f32_16x16x32_bf16 v[40:43], v[208:211], v[160:163], v[40:43]
    ds_read_b64_tr_b16 v[204:205], v20 offset:20480
    ds_read_b64_tr_b16 v[206:207], v20 offset:25600
    v_mfma_f32_16x16x32_bf16 v[80:83], v[208:211], v[164:167], v[80:83]
    s_add_u32 s11, s47, 3
    s_waitcnt lgkmcnt(8)
    v_mfma_f32_16x16x32_bf16 v[44:47], v[212:215], v[160:163], v[44:47]
    ds_read_b64_tr_b16 v[208:209], v21 offset:20480
    ds_read_b64_tr_b16 v[210:211], v21 offset:25600
    v_mfma_f32_16x16x32_bf16 v[84:87], v[212:215], v[164:167], v[84:87]
    s_and_b32 s11, s11, 3
    s_waitcnt lgkmcnt(8)
    v_mfma_f32_16x16x32_bf16 v[48:51], v[216:219], v[160:163], v[48:51]
    ds_read_b64_tr_b16 v[212:213], v20 offset:20544
    ds_read_b64_tr_b16 v[214:215], v20 offset:25664
    v_mfma_f32_16x16x32_bf16 v[88:91], v[216:219], v[164:167], v[88:91]
    s_lshl2_add_u32 s11, s46, s11
    s_waitcnt lgkmcnt(8)
    v_mfma_f32_16x16x32_bf16 v[52:55], v[220:223], v[160:163], v[52:55]
    ds_read_b64_tr_b16 v[216:217], v21 offset:20544
    ds_read_b64_tr_b16 v[218:219], v21 offset:25664
    v_mfma_f32_16x16x32_bf16 v[92:95], v[220:223], v[164:167], v[92:95]
    s_mul_i32 s11, s11, 3072
    s_waitcnt lgkmcnt(8)
    v_mfma_f32_16x16x32_bf16 v[56:59], v[200:203], v[160:163], v[56:59]
    ds_read_b64_tr_b16 v[220:221], v20 offset:20608
    ds_read_b64_tr_b16 v[222:223], v20 offset:25728
    v_mfma_f32_16x16x32_bf16 v[96:99], v[200:203], v[164:167], v[96:99]
    s_add_u32 s11, s11, s13
    s_waitcnt lgkmcnt(8)
    v_mfma_f32_16x16x32_bf16 v[60:63], v[204:207], v[160:163], v[60:63]
    ds_read_b64_tr_b16 v[200:201], v18 offset:39040
    ds_read_b64_tr_b16 v[202:203], v18 offset:44160
    v_mfma_f32_16x16x32_bf16 v[100:103], v[204:207], v[164:167], v[100:103]
    s_add_u32 s12, s11, s16
    s_waitcnt lgkmcnt(8)
    v_mfma_f32_16x16x32_bf16 v[64:67], v[208:211], v[160:163], v[64:67]
    ds_read_b64_tr_b16 v[204:205], v19 offset:39040
    ds_read_b64_tr_b16 v[206:207], v19 offset:44160
    v_mfma_f32_16x16x32_bf16 v[104:107], v[208:211], v[164:167], v[104:107]
    buffer_load_dwordx4 v[128:131], v2, s[40:43], s11 offen offset:0 sc1
    s_waitcnt lgkmcnt(8)
    v_mfma_f32_16x16x32_bf16 v[68:71], v[212:215], v[160:163], v[68:71]
    ds_read_b64_tr_b16 v[208:209], v18 offset:39104
    ds_read_b64_tr_b16 v[210:211], v18 offset:44224
    v_mfma_f32_16x16x32_bf16 v[108:111], v[212:215], v[164:167], v[108:111]
    buffer_load_dwordx4 v[132:135], v2, s[40:43], s12 offen offset:0 sc1
    s_waitcnt lgkmcnt(8)
    v_mfma_f32_16x16x32_bf16 v[72:75], v[216:219], v[160:163], v[72:75]
    ds_read_b64_tr_b16 v[212:213], v19 offset:39104
    ds_read_b64_tr_b16 v[214:215], v19 offset:44224
    v_mfma_f32_16x16x32_bf16 v[112:115], v[216:219], v[164:167], v[112:115]
    buffer_load_dwordx4 v[136:139], v2, s[40:43], s11 offen offset:1024 sc1
    s_waitcnt lgkmcnt(8)
    v_mfma_f32_16x16x32_bf16 v[76:79], v[220:223], v[160:163], v[76:79]
    ds_read_b64_tr_b16 v[216:217], v18 offset:39168
    ds_read_b64_tr_b16 v[218:219], v18 offset:44288
    v_mfma_f32_16x16x32_bf16 v[116:119], v[220:223], v[164:167], v[116:119]
    buffer_load_dwordx4 v[140:143], v2, s[40:43], s12 offen offset:1024 sc1
    s_waitcnt vmcnt(9)
    v_mov_b32 v39, 8
    ds_write_b32 v29, v39
    s_waitcnt lgkmcnt(9)
    v_mfma_f32_16x16x32_bf16 v[40:43], v[200:203], v[168:171], v[40:43]
    ds_read_b64_tr_b16 v[220:221], v20 offset:39040
    ds_read_b64_tr_b16 v[222:223], v20 offset:44160
    v_mfma_f32_16x16x32_bf16 v[80:83], v[200:203], v[172:175], v[80:83]
    buffer_load_dwordx4 v[144:147], v2, s[40:43], s11 offen offset:2048 sc1
    s_waitcnt lgkmcnt(9)
    v_mfma_f32_16x16x32_bf16 v[44:47], v[204:207], v[168:171], v[44:47]
    ds_read_b64_tr_b16 v[200:201], v21 offset:39040
    ds_read_b64_tr_b16 v[202:203], v21 offset:44160
    v_mfma_f32_16x16x32_bf16 v[84:87], v[204:207], v[172:175], v[84:87]
    s_waitcnt lgkmcnt(9)
    v_mfma_f32_16x16x32_bf16 v[48:51], v[208:211], v[168:171], v[48:51]
    ds_read_b64_tr_b16 v[204:205], v20 offset:39104
    ds_read_b64_tr_b16 v[206:207], v20 offset:44224
    v_mfma_f32_16x16x32_bf16 v[88:91], v[208:211], v[172:175], v[88:91]
    s_waitcnt lgkmcnt(9)
    v_mfma_f32_16x16x32_bf16 v[52:55], v[212:215], v[168:171], v[52:55]
    ds_read_b64_tr_b16 v[208:209], v21 offset:39104
    ds_read_b64_tr_b16 v[210:211], v21 offset:44224
    v_mfma_f32_16x16x32_bf16 v[92:95], v[212:215], v[172:175], v[92:95]
    s_waitcnt lgkmcnt(9)
    v_mfma_f32_16x16x32_bf16 v[56:59], v[216:219], v[168:171], v[56:59]
    ds_read_b64_tr_b16 v[212:213], v20 offset:39168
    ds_read_b64_tr_b16 v[214:215], v20 offset:44288
    v_mfma_f32_16x16x32_bf16 v[96:99], v[216:219], v[172:175], v[96:99]
    s_waitcnt lgkmcnt(8)
    v_mfma_f32_16x16x32_bf16 v[60:63], v[220:223], v[168:171], v[60:63]
    ds_read_b64_tr_b16 v[216:217], v18 offset:49280
    ds_read_b64_tr_b16 v[218:219], v18 offset:54400
    v_mfma_f32_16x16x32_bf16 v[100:103], v[220:223], v[172:175], v[100:103]
    buffer_load_dwordx4 v[148:151], v2, s[40:43], s12 offen offset:2048 sc1
    s_waitcnt lgkmcnt(8)
    v_mfma_f32_16x16x32_bf16 v[64:67], v[200:203], v[168:171], v[64:67]
    ds_read_b64_tr_b16 v[220:221], v19 offset:49280
    ds_read_b64_tr_b16 v[222:223], v19 offset:54400
    v_mfma_f32_16x16x32_bf16 v[104:107], v[200:203], v[172:175], v[104:107]
    s_waitcnt lgkmcnt(8)
    v_mfma_f32_16x16x32_bf16 v[68:71], v[204:207], v[168:171], v[68:71]
    ds_read_b64_tr_b16 v[200:201], v18 offset:49344
    ds_read_b64_tr_b16 v[202:203], v18 offset:54464
    v_mfma_f32_16x16x32_bf16 v[108:111], v[204:207], v[172:175], v[108:111]
    s_waitcnt lgkmcnt(8)
    v_mfma_f32_16x16x32_bf16 v[72:75], v[208:211], v[168:171], v[72:75]
    ds_read_b64_tr_b16 v[204:205], v19 offset:49344
    ds_read_b64_tr_b16 v[206:207], v19 offset:54464
    v_mfma_f32_16x16x32_bf16 v[112:115], v[208:211], v[172:175], v[112:115]
    s_waitcnt lgkmcnt(8)
    v_mfma_f32_16x16x32_bf16 v[76:79], v[212:215], v[168:171], v[76:79]
    ds_read_b64_tr_b16 v[208:209], v18 offset:49408
    ds_read_b64_tr_b16 v[210:211], v18 offset:54528
    v_mfma_f32_16x16x32_bf16 v[116:119], v[212:215], v[172:175], v[116:119]
    s_waitcnt vmcnt(9)
    s_waitcnt lgkmcnt(8)
    v_mfma_f32_16x16x32_bf16 v[40:43], v[216:219], v[176:179], v[40:43]
    ds_read_b64_tr_b16 v[212:213], v20 offset:49280
    ds_read_b64_tr_b16 v[214:215], v20 offset:54400
    v_mfma_f32_16x16x32_bf16 v[80:83], v[216:219], v[180:183], v[80:83]
    s_waitcnt lgkmcnt(8)
    v_mfma_f32_16x16x32_bf16 v[44:47], v[220:223], v[176:179], v[44:47]
    ds_read_b64_tr_b16 v[216:217], v21 offset:49280
    ds_read_b64_tr_b16 v[218:219], v21 offset:54400
    v_mfma_f32_16x16x32_bf16 v[84:87], v[220:223], v[180:183], v[84:87]
    s_waitcnt lgkmcnt(8)
    v_mfma_f32_16x16x32_bf16 v[48:51], v[200:203], v[176:179], v[48:51]
    ds_read_b64_tr_b16 v[220:221], v20 offset:49344
    ds_read_b64_tr_b16 v[222:223], v20 offset:54464
    v_mfma_f32_16x16x32_bf16 v[88:91], v[200:203], v[180:183], v[88:91]
    s_waitcnt lgkmcnt(8)
    v_mfma_f32_16x16x32_bf16 v[52:55], v[204:207], v[176:179], v[52:55]
    ds_read_b64_tr_b16 v[200:201], v21 offset:49344
    ds_read_b64_tr_b16 v[202:203], v21 offset:54464
    v_mfma_f32_16x16x32_bf16 v[92:95], v[204:207], v[180:183], v[92:95]
    s_waitcnt lgkmcnt(8)
    v_mfma_f32_16x16x32_bf16 v[56:59], v[208:211], v[176:179], v[56:59]
    ds_read_b64_tr_b16 v[204:205], v20 offset:49408
    ds_read_b64_tr_b16 v[206:207], v20 offset:54528
    v_mfma_f32_16x16x32_bf16 v[96:99], v[208:211], v[180:183], v[96:99]
    s_waitcnt lgkmcnt(8)
    v_mfma_f32_16x16x32_bf16 v[60:63], v[212:215], v[176:179], v[60:63]
    ds_read_b64_tr_b16 v[208:209], v18 offset:59520
    ds_read_b64_tr_b16 v[210:211], v18 offset:64640
    v_mfma_f32_16x16x32_bf16 v[100:103], v[212:215], v[180:183], v[100:103]
    ds_read_b128 v[32:35], v27 offset:0
    s_waitcnt lgkmcnt(9)
    v_mfma_f32_16x16x32_bf16 v[64:67], v[216:219], v[176:179], v[64:67]
    ds_read_b64_tr_b16 v[212:213], v19 offset:59520
    ds_read_b64_tr_b16 v[214:215], v19 offset:64640
    v_mfma_f32_16x16x32_bf16 v[104:107], v[216:219], v[180:183], v[104:107]
    s_waitcnt lgkmcnt(9)
    v_mfma_f32_16x16x32_bf16 v[68:71], v[220:223], v[176:179], v[68:71]
    ds_read_b64_tr_b16 v[216:217], v18 offset:59584
    ds_read_b64_tr_b16 v[218:219], v18 offset:64704
    v_mfma_f32_16x16x32_bf16 v[108:111], v[220:223], v[180:183], v[108:111]
    s_waitcnt lgkmcnt(9)
    v_mfma_f32_16x16x32_bf16 v[72:75], v[200:203], v[176:179], v[72:75]
    ds_read_b64_tr_b16 v[220:221], v19 offset:59584
    ds_read_b64_tr_b16 v[222:223], v19 offset:64704
    v_mfma_f32_16x16x32_bf16 v[112:115], v[200:203], v[180:183], v[112:115]
    s_waitcnt lgkmcnt(9)
    v_mfma_f32_16x16x32_bf16 v[76:79], v[204:207], v[176:179], v[76:79]
    ds_read_b64_tr_b16 v[200:201], v18 offset:59648
    ds_read_b64_tr_b16 v[202:203], v18 offset:64768
    v_mfma_f32_16x16x32_bf16 v[116:119], v[204:207], v[180:183], v[116:119]
    s_waitcnt vmcnt(7)
    v_min3_u32 v32, v32, v33, v34
    v_min_u32 v32, v32, v35
    v_cmp_gt_u32 vcc, 1, v32
    s_nop 1
    s_cmp_lg_u64 vcc, 0
    s_cbranch_scc1 L_gslow_13
L_gok_14:
    s_waitcnt lgkmcnt(9)
    v_mfma_f32_16x16x32_bf16 v[40:43], v[208:211], v[120:123], v[40:43]
    ds_read_b64_tr_b16 v[204:205], v20 offset:59520
    ds_read_b64_tr_b16 v[206:207], v20 offset:64640
    v_mfma_f32_16x16x32_bf16 v[80:83], v[208:211], v[124:127], v[80:83]
    s_waitcnt lgkmcnt(8)
    v_mfma_f32_16x16x32_bf16 v[44:47], v[212:215], v[120:123], v[44:47]
    ds_read_b64_tr_b16 v[208:209], v21 offset:59520
    ds_read_b64_tr_b16 v[210:211], v21 offset:64640
    v_mfma_f32_16x16x32_bf16 v[84:87], v[212:215], v[124:127], v[84:87]
    s_waitcnt lgkmcnt(8)
    v_mfma_f32_16x16x32_bf16 v[48:51], v[216:219], v[120:123], v[48:51]
    ds_read_b64_tr_b16 v[212:213], v20 offset:59584
    ds_read_b64_tr_b16 v[214:215], v20 offset:64704
    v_mfma_f32_16x16x32_bf16 v[88:91], v[216:219], v[124:127], v[88:91]
    s_waitcnt lgkmcnt(8)
    v_mfma_f32_16x16x32_bf16 v[52:55], v[220:223], v[120:123], v[52:55]
    ds_read_b64_tr_b16 v[216:217], v21 offset:59584
    ds_read_b64_tr_b16 v[218:219], v21 offset:64704
    v_mfma_f32_16x16x32_bf16 v[92:95], v[220:223], v[124:127], v[92:95]
    s_waitcnt lgkmcnt(8)
    v_mfma_f32_16x16x32_bf16 v[56:59], v[200:203], v[120:123], v[56:59]
    ds_read_b64_tr_b16 v[220:221], v20 offset:59648
    ds_read_b64_tr_b16 v[222:223], v20 offset:64768
    v_mfma_f32_16x16x32_bf16 v[96:99], v[200:203], v[124:127], v[96:99]
    s_waitcnt lgkmcnt(8)
    v_mfma_f32_16x16x32_bf16 v[60:63], v[204:207], v[120:123], v[60:63]
    ds_read_b64_tr_b16 v[200:201], v14 offset:30720
    ds_read_b64_tr_b16 v[202:203], v14 offset:35840
    v_mfma_f32_16x16x32_bf16 v[100:103], v[204:207], v[124:127], v[100:103]
    s_waitcnt lgkmcnt(8)
    v_mfma_f32_16x16x32_bf16 v[64:67], v[208:211], v[120:123], v[64:67]
    ds_read_b64_tr_b16 v[204:205], v15 offset:30720
    ds_read_b64_tr_b16 v[206:207], v15 offset:35840
    v_mfma_f32_16x16x32_bf16 v[104:107], v[208:211], v[124:127], v[104:107]
    s_waitcnt lgkmcnt(8)
    v_mfma_f32_16x16x32_bf16 v[68:71], v[212:215], v[120:123], v[68:71]
    ds_read_b64_tr_b16 v[208:209], v14 offset:30784
    ds_read_b64_tr_b16 v[210:211], v14 offset:35904
    v_mfma_f32_16x16x32_bf16 v[108:111], v[212:215], v[124:127], v[108:111]
    s_waitcnt lgkmcnt(8)
    v_mfma_f32_16x16x32_bf16 v[72:75], v[216:219], v[120:123], v[72:75]
    ds_read_b64_tr_b16 v[212:213], v15 offset:30784
    ds_read_b64_tr_b16 v[214:215], v15 offset:35904
    v_mfma_f32_16x16x32_bf16 v[112:115], v[216:219], v[124:127], v[112:115]
    s_waitcnt lgkmcnt(8)
    v_mfma_f32_16x16x32_bf16 v[76:79], v[220:223], v[120:123], v[76:79]
    ds_read_b64_tr_b16 v[216:217], v14 offset:30848
    ds_read_b64_tr_b16 v[218:219], v14 offset:35968
    v_mfma_f32_16x16x32_bf16 v[116:119], v[220:223], v[124:127], v[116:119]
    s_waitcnt vmcnt(4)
    v_mov_b32 v39, 11
    ds_write_b32 v29, v39
    s_waitcnt lgkmcnt(9)
    v_mfma_f32_16x16x32_bf16 v[40:43], v[200:203], v[128:131], v[40:43]
    ds_read_b64_tr_b16 v[220:221], v16 offset:30720
    ds_read_b64_tr_b16 v[222:223], v16 offset:35840
    v_mfma_f32_16x16x32_bf16 v[80:83], v[200:203], v[132:135], v[80:83]
    s_waitcnt lgkmcnt(9)
    v_mfma_f32_16x16x32_bf16 v[44:47], v[204:207], v[128:131], v[44:47]
    ds_read_b64_tr_b16 v[200:201], v17 offset:30720
    ds_read_b64_tr_b16 v[202:203], v17 offset:35840
    v_mfma_f32_16x16x32_bf16 v[84:87], v[204:207], v[132:135], v[84:87]
    s_waitcnt lgkmcnt(9)
    v_mfma_f32_16x16x32_bf16 v[48:51], v[208:211], v[128:131], v[48:51]
    ds_read_b64_tr_b16 v[204:205], v16 offset:30784
    ds_read_b64_tr_b16 v[206:207], v16 offset:35904
    v_mfma_f32_16x16x32_bf16 v[88:91], v[208:211], v[132:135], v[88:91]
    s_waitcnt lgkmcnt(9)
    v_mfma_f32_16x16x32_bf16 v[52:55], v[212:215], v[128:131], v[52:55]
    ds_read_b64_tr_b16 v[208:209], v17 offset:30784
    ds_read_b64_tr_b16 v[210:211], v17 offset:35904
    v_mfma_f32_16x16x32_bf16 v[92:95], v[212:215], v[132:135], v[92:95]
    s_waitcnt lgkmcnt(9)
    v_mfma_f32_16x16x32_bf16 v[56:59], v[216:219], v[128:131], v[56:59]
    ds_read_b64_tr_b16 v[212:213], v16 offset:30848
    ds_read_b64_tr_b16 v[214:215], v16 offset:35968
    v_mfma_f32_16x16x32_bf16 v[96:99], v[216:219], v[132:135], v[96:99]
    s_waitcnt lgkmcnt(8)
    v_mfma_f32_16x16x32_bf16 v[60:63], v[220:223], v[128:131], v[60:63]
    ds_read_b64_tr_b16 v[216:217], v14 offset:40960
    ds_read_b64_tr_b16 v[218:219], v14 offset:46080
    v_mfma_f32_16x16x32_bf16 v[100:103], v[220:223], v[132:135], v[100:103]
    s_waitcnt lgkmcnt(8)
    v_mfma_f32_16x16x32_bf16 v[64:67], v[200:203], v[128:131], v[64:67]
    ds_read_b64_tr_b16 v[220:221], v15 offset:40960
    ds_read_b64_tr_b16 v[222:223], v15 offset:46080
    v_mfma_f32_16x16x32_bf16 v[104:107], v[200:203], v[132:135], v[104:107]
    s_waitcnt lgkmcnt(8)
    v_mfma_f32_16x16x32_bf16 v[68:71], v[204:207], v[128:131], v[68:71]
    ds_read_b64_tr_b16 v[200:201], v14 offset:41024
    ds_read_b64_tr_b16 v[202:203], v14 offset:46144
    v_mfma_f32_16x16x32_bf16 v[108:111], v[204:207], v[132:135], v[108:111]
    s_waitcnt lgkmcnt(8)
    v_mfma_f32_16x16x32_bf16 v[72:75], v[208:211], v[128:131], v[72:75]
    ds_read_b64_tr_b16 v[204:205], v15 offset:41024
    ds_read_b64_tr_b16 v[206:207], v15 offset:46144
    v_mfma_f32_16x16x32_bf16 v[112:115], v[208:211], v[132:135], v[112:115]
    s_waitcnt lgkmcnt(8)
    v_mfma_f32_16x16x32_bf16 v[76:79], v[212:215], v[128:131], v[76:79]
    ds_read_b64_tr_b16 v[208:209], v14 offset:41088
    ds_read_b64_tr_b16 v[210:211], v14 offset:46208
    v_mfma_f32_16x16x32_bf16 v[116:119], v[212:215], v[132:135], v[116:119]
    s_waitcnt vmcnt(2)
    s_waitcnt lgkmcnt(8)
    v_mfma_f32_16x16x32_bf16 v[40:43], v[216:219], v[136:139], v[40:43]
    ds_read_b64_tr_b16 v[212:213], v16 offset:40960
    ds_read_b64_tr_b16 v[214:215], v16 offset:46080
    v_mfma_f32_16x16x32_bf16 v[80:83], v[216:219], v[140:143], v[80:83]
    s_mov_b64 exec, 15
    buffer_load_dword v31, v28, s[40:43], s18 offen sc1
    s_mov_b64 exec, -1
    s_waitcnt lgkmcnt(8)
    v_mfma_f32_16x16x32_bf16 v[44:47], v[220:223], v[136:139], v[44:47]
    ds_read_b64_tr_b16 v[216:217], v17 offset:40960
    ds_read_b64_tr_b16 v[218:219], v17 offset:46080
    v_mfma_f32_16x16x32_bf16 v[84:87], v[220:223], v[140:143], v[84:87]
    s_waitcnt lgkmcnt(8)
    v_mfma_f32_16x16x32_bf16 v[48:51], v[200:203], v[136:139], v[48:51]
    ds_read_b64_tr_b16 v[220:221], v16 offset:41024
    ds_read_b64_tr_b16 v[222:223], v16 offset:46144
    v_mfma_f32_16x16x32_bf16 v[88:91], v[200:203], v[140:143], v[88:91]
    s_waitcnt lgkmcnt(8)
    v_mfma_f32_16x16x32_bf16 v[52:55], v[204:207], v[136:139], v[52:55]
    ds_read_b64_tr_b16 v[200:201], v17 offset:41024
    ds_read_b64_tr_b16 v[202:203], v17 offset:46144
    v_mfma_f32_16x16x32_bf16 v[92:95], v[204:207], v[140:143], v[92:95]
    s_waitcnt lgkmcnt(8)
    v_mfma_f32_16x16x32_bf16 v[56:59], v[208:211], v[136:139], v[56:59]
    ds_read_b64_tr_b16 v[204:205], v16 offset:41088
    ds_read_b64_tr_b16 v[206:207], v16 offset:46208
    v_mfma_f32_16x16x32_bf16 v[96:99], v[208:211], v[140:143], v[96:99]
    s_waitcnt lgkmcnt(8)
    v_mfma_f32_16x16x32_bf16 v[60:63], v[212:215], v[136:139], v[60:63]
    ds_read_b64_tr_b16 v[208:209], v14 offset:51200
    ds_read_b64_tr_b16 v[210:211], v14 offset:56320
    v_mfma_f32_16x16x32_bf16 v[100:103], v[212:215], v[140:143], v[100:103]
    s_waitcnt lgkmcnt(8)
    v_mfma_f32_16x16x32_bf16 v[64:67], v[216:219], v[136:139], v[64:67]
    ds_read_b64_tr_b16 v[212:213], v15 offset:51200
    ds_read_b64_tr_b16 v[214:215], v15 offset:56320
    v_mfma_f32_16x16x32_bf16 v[104:107], v[216:219], v[140:143], v[104:107]
    s_waitcnt lgkmcnt(8)
    v_mfma_f32_16x16x32_bf16 v[68:71], v[220:223], v[136:139], v[68:71]
    ds_read_b64_tr_b16 v[216:217], v14 offset:51264
    ds_read_b64_tr_b16 v[218:219], v14 offset:56384
    v_mfma_f32_16x16x32_bf16 v[108:111], v[220:223], v[140:143], v[108:111]
    s_waitcnt lgkmcnt(8)
    v_mfma_f32_16x16x32_bf16 v[72:75], v[200:203], v[136:139], v[72:75]
    ds_read_b64_tr_b16 v[220:221], v15 offset:51264
    ds_read_b64_tr_b16 v[222:223], v15 offset:56384
    v_mfma_f32_16x16x32_bf16 v[112:115], v[200:203], v[140:143], v[112:115]
    s_waitcnt lgkmcnt(8)
    v_mfma_f32_16x16x32_bf16 v[76:79], v[204:207], v[136:139], v[76:79]
    ds_read_b64_tr_b16 v[200:201], v14 offset:51328
    ds_read_b64_tr_b16 v[202:203], v14 offset:56448
    v_mfma_f32_16x16x32_bf16 v[116:119], v[204:207], v[140:143], v[116:119]
    s_waitcnt vmcnt(1)
    s_waitcnt lgkmcnt(8)
    v_mfma_f32_16x16x32_bf16 v[40:43], v[208:211], v[144:147], v[40:43]
    ds_read_b64_tr_b16 v[204:205], v16 offset:51200
    ds_read_b64_tr_b16 v[206:207], v16 offset:56320
    v_mfma_f32_16x16x32_bf16 v[80:83], v[208:211], v[148:151], v[80:83]
    s_waitcnt lgkmcnt(8)
    v_mfma_f32_16x16x32_bf16 v[44:47], v[212:215], v[144:147], v[44:47]
    ds_read_b64_tr_b16 v[208:209], v17 offset:51200
    ds_read_b64_tr_b16 v[210:211], v17 offset:56320
    v_mfma_f32_16x16x32_bf16 v[84:87], v[212:215], v[148:151], v[84:87]
    s_waitcnt lgkmcnt(8)
    v_mfma_f32_16x16x32_bf16 v[48:51], v[216:219], v[144:147], v[48:51]
    ds_read_b64_tr_b16 v[212:213], v16 offset:51264
    ds_read_b64_tr_b16 v[214:215], v16 offset:56384
    v_mfma_f32_16x16x32_bf16 v[88:91], v[216:219], v[148:151], v[88:91]
    s_waitcnt lgkmcnt(8)
    v_mfma_f32_16x16x32_bf16 v[52:55], v[220:223], v[144:147], v[52:55]
    ds_read_b64_tr_b16 v[216:217], v17 offset:51264
    ds_read_b64_tr_b16 v[218:219], v17 offset:56384
    v_mfma_f32_16x16x32_bf16 v[92:95], v[220:223], v[148:151], v[92:95]
    s_waitcnt lgkmcnt(8)
    v_mfma_f32_16x16x32_bf16 v[56:59], v[200:203], v[144:147], v[56:59]
    ds_read_b64_tr_b16 v[220:221], v16 offset:51328
    ds_read_b64_tr_b16 v[222:223], v16 offset:56448
    v_mfma_f32_16x16x32_bf16 v[96:99], v[200:203], v[148:151], v[96:99]
    s_waitcnt lgkmcnt(8)
    v_mfma_f32_16x16x32_bf16 v[60:63], v[204:207], v[144:147], v[60:63]
    v_mfma_f32_16x16x32_bf16 v[100:103], v[204:207], v[148:151], v[100:103]
    s_waitcnt lgkmcnt(6)
    v_mfma_f32_16x16x32_bf16 v[64:67], v[208:211], v[144:147], v[64:67]
    v_mfma_f32_16x16x32_bf16 v[104:107], v[208:211], v[148:151], v[104:107]
    s_waitcnt lgkmcnt(4)
    v_mfma_f32_16x16x32_bf16 v[68:71], v[212:215], v[144:147], v[68:71]
    v_mfma_f32_16x16x32_bf16 v[108:111], v[212:215], v[148:151], v[108:111]
    s_waitcnt lgkmcnt(2)
    v_mfma_f32_16x16x32_bf16 v[72:75], v[216:219], v[144:147], v[72:75]
    v_mfma_f32_16x16x32_bf16 v[112:115], v[216:219], v[148:151], v[112:115]
    s_waitcnt lgkmcnt(0)
    v_mfma_f32_16x16x32_bf16 v[76:79], v[220:223], v[144:147], v[76:79]
    v_mfma_f32_16x16x32_bf16 v[116:119], v[220:223], v[148:151], v[116:119]
    v_mov_b32 v39, 14
    ds_write_b32 v29, v39
    ds_read_b128 v[32:35], v27
    s_waitcnt vmcnt(0)
    v_cmp_ne_u32 vcc, s49, v31
    s_nop 1
    s_and_b32 s53, vcc_lo, 15
    s_cbranch_scc1 L_slow_16
L_ok_17:
    s_bitcmp1_b32 s46, 0
    s_cselect_b32 s12, 50, 48
    s_mul_i32 s11, s46, 10
    s_add_u32 s11, s11, s12
    s_lshl_b32 s11, s11, 10
    s_add_u32 s11, s11, s13
    s_add_u32 s12, s11, s16
    buffer_load_dwordx4 v[152:155], v2, s[40:43], s11 offen offset:0 sc1
    buffer_load_dwordx4 v[156:159], v2, s[40:43], s12 offen offset:0 sc1
    buffer_load_dwordx4 v[160:163], v2, s[40:43], s11 offen offset:1024 sc1
    buffer_load_dwordx4 v[164:167], v2, s[40:43], s12 offen offset:1024 sc1
    buffer_load_dwordx4 v[168:171], v2, s[40:43], s11 offen offset:2048 sc1
    buffer_load_dwordx4 v[172:175], v2, s[40:43], s12 offen offset:2048 sc1
    buffer_load_dwordx4 v[176:179], v2, s[40:43], s11 offen offset:3072 sc1
    buffer_load_dwordx4 v[180:183], v2, s[40:43], s12 offen offset:3072 sc1
    v_mov_b32 v18, v24
    v_xor_b32 v19, 32, v24
    v_xor_b32 v20, 64, v24
    v_xor_b32 v21, 96, v24
    v_add_u32 v14, 39040, v18
    v_add_u32 v15, 39040, v19
    v_add_u32 v16, 39040, v20
    v_add_u32 v17, 39040, v21
    v_and_b32 v36, 3, v1
    v_cmp_eq_u32 vcc, 2, v36
    v_xor_b32 v36, s46, v36
    v_lshl_add_u32 v28, v36, 14, s22
    v_add_u32 v36, 512, v28
    v_cndmask_b32 v28, v28, v36, vcc
    s_lshl_b32 s50, s46, 14
    s_add_u32 s18, s22, s50
    v_mov_b32 v36, s49
    s_waitcnt lgkmcnt(0)
    v_min3_u32 v32, v32, v33, v34
    v_min_u32 v32, v32, v35
    v_cmp_gt_u32 vcc, 4, v32
    s_nop 1
    s_cmp_lg_u64 vcc, 0
    s_cbranch_scc1 L_gslow_19
L_gok_20:
    ds_read_b128 v[200:203], v18 offset:0
    ds_read_b128 v[204:207], v18 offset:2048
    ds_read_b128 v[208:211], v18 offset:4096
    ds_read_b128 v[212:215], v18 offset:6144
    ds_read_b128 v[216:219], v18 offset:8192
    s_waitcnt vmcnt(6)
    s_waitcnt lgkmcnt(4)
    v_mfma_f32_16x16x32_bf16 v[40:43], v[200:203], v[152:155], v[40:43]
    ds_read_b128 v[220:223], v19 offset:0
    v_mfma_f32_16x16x32_bf16 v[80:83], v[200:203], v[156:159], v[80:83]
    s_bitcmp1_b32 s46, 0
    s_cselect_b32 s12, 48, 56
    s_mul_i32 s11, s46, 10
    s_waitcnt lgkmcnt(4)
    v_mfma_f32_16x16x32_bf16 v[44:47], v[204:207], v[152:155], v[44:47]
    ds_read_b128 v[200:203], v19 offset:2048
    v_mfma_f32_16x16x32_bf16 v[84:87], v[204:207], v[156:159], v[84:87]
    s_add_u32 s11, s11, s12
    s_lshl_b32 s11, s11, 10
    s_waitcnt lgkmcnt(4)
    v_mfma_f32_16x16x32_bf16 v[48:51], v[208:211], v[152:155], v[48:51]
    ds_read_b128 v[204:207], v19 offset:4096
    v_mfma_f32_16x16x32_bf16 v[88:91], v[208:211], v[156:159], v[88:91]
    s_add_u32 s11, s11, s13
    s_waitcnt lgkmcnt(4)
    v_mfma_f32_16x16x32_bf16 v[52:55], v[212:215], v[152:155], v[52:55]
    ds_read_b128 v[208:211], v19 offset:6144
    v_mfma_f32_16x16x32_bf16 v[92:95], v[212:215], v[156:159], v[92:95]
    s_add_u32 s12, s11, s16
    buffer_load_dwordx4 v[184:187], v2, s[40:43], s11 offen offset:0 sc1
    s_waitcnt lgkmcnt(4)
    v_mfma_f32_16x16x32_bf16 v[56:59], v[216:219], v[152:155], v[56:59]
    ds_read_b128 v[212:215], v19 offset:8192
    v_mfma_f32_16x16x32_bf16 v[96:99], v[216:219], v[156:159], v[96:99]
    buffer_load_dwordx4 v[188:191], v2, s[40:43], s12 offen offset:0 sc1
    s_waitcnt vmcnt(6)
    s_waitcnt lgkmcnt(4)
    v_mfma_f32_16x16x32_bf16 v[40:43], v[220:223], v[160:163], v[40:43]
    ds_read_b128 v[216:219], v20 offset:0
    v_mfma_f32_16x16x32_bf16 v[80:83], v[220:223], v[164:167], v[80:83]
    buffer_load_dwordx4 v[192:195], v2, s[40:43], s11 offen offset:1024 sc1
    s_waitcnt lgkmcnt(4)
    v_mfma_f32_16x16x32_bf16 v[44:47], v[200:203], v[160:163], v[44:47]
    ds_read_b128 v[220:223], v20 offset:2048
    v_mfma_f32_16x16x32_bf16 v[84:87], v[200:203], v[164:167], v[84:87]
    s_waitcnt lgkmcnt(4)
    v_mfma_f32_16x16x32_bf16 v[48:51], v[204:207], v[160:163], v[48:51]
    ds_read_b128 v[200:203], v20 offset:4096
    v_mfma_f32_16x16x32_bf16 v[88:91], v[204:207], v[164:167], v[88:91]
    buffer_load_dwordx4 v[196:199], v2, s[40:43], s12 offen offset:1024 sc1
    s_waitcnt lgkmcnt(4)
    v_mfma_f32_16x16x32_bf16 v[52:55], v[208:211], v[160:163], v[52:55]
    ds_read_b128 v[204:207], v20 offset:6144
    v_mfma_f32_16x16x32_bf16 v[92:95], v[208:211], v[164:167], v[92:95]
    s_waitcnt lgkmcnt(4)
    v_mfma_f32_16x16x32_bf16 v[56:59], v[212:215], v[160:163], v[56:59]
    ds_read_b128 v[208:211], v20 offset:8192
    v_mfma_f32_16x16x32_bf16 v[96:99], v[212:215], v[164:167], v[96:99]
    s_waitcnt vmcnt(6)
    s_waitcnt lgkmcnt(4)
    v_mfma_f32_16x16x32_bf16 v[40:43], v[216:219], v[168:171], v[40:43]
    ds_read_b128 v[212:215], v21 offset:0
    v_mfma_f32_16x16x32_bf16 v[80:83], v[216:219], v[172:175], v[80:83]
    s_bitcmp1_b32 s46, 0
    s_cselect_b32 s12, 54, 52
    s_mul_i32 s11, s46, 10
    s_waitcnt lgkmcnt(4)
    v_mfma_f32_16x16x32_bf16 v[44:47], v[220:223], v[168:171], v[44:47]
    ds_read_b128 v[216:219], v21 offset:2048
    v_mfma_f32_16x16x32_bf16 v[84:87], v[220:223], v[172:175], v[84:87]
    s_add_u32 s11, s11, s12
    s_lshl_b32 s11, s11, 10
    s_waitcnt lgkmcnt(4)
    v_mfma_f32_16x16x32_bf16 v[48:51], v[200:203], v[168:171], v[48:51]
    ds_read_b128 v[220:223], v21 offset:4096
    v_mfma_f32_16x16x32_bf16 v[88:91], v[200:203], v[172:175], v[88:91]
    s_add_u32 s11, s11, s13
    s_waitcnt lgkmcnt(4)
    v_mfma_f32_16x16x32_bf16 v[52:55], v[204:207], v[168:171], v[52:55]
    ds_read_b128 v[200:203], v21 offset:6144
    v_mfma_f32_16x16x32_bf16 v[92:95], v[204:207], v[172:175], v[92:95]
    s_add_u32 s12, s11, s16
    buffer_load_dwordx4 v[120:123], v2, s[40:43], s11 offen offset:0 sc1
    s_waitcnt lgkmcnt(4)
    v_mfma_f32_16x16x32_bf16 v[56:59], v[208:211], v[168:171], v[56:59]
    ds_read_b128 v[204:207], v21 offset:8192
    v_mfma_f32_16x16x32_bf16 v[96:99], v[208:211], v[172:175], v[96:99]
    buffer_load_dwordx4 v[124:127], v2, s[40:43], s12 offen offset:0 sc1
    s_waitcnt vmcnt(6)
    s_waitcnt lgkmcnt(4)
    v_mfma_f32_16x16x32_bf16 v[40:43], v[212:215], v[176:179], v[40:43]
    ds_read_b128 v[208:211], v22 offset:0
    v_mfma_f32_16x16x32_bf16 v[80:83], v[212:215], v[180:183], v[80:83]
    buffer_load_dwordx4 v[128:131], v2, s[40:43], s11 offen offset:1024 sc1
    s_waitcnt lgkmcnt(4)
    v_mfma_f32_16x16x32_bf16 v[44:47], v[216:219], v[176:179], v[44:47]
    ds_read_b128 v[212:215], v22 offset:1024
    v_mfma_f32_16x16x32_bf16 v[84:87], v[216:219], v[180:183], v[84:87]
    s_waitcnt lgkmcnt(4)
    v_mfma_f32_16x16x32_bf16 v[48:51], v[220:223], v[176:179], v[48:51]
    ds_read_b128 v[216:219], v22 offset:2048
    v_mfma_f32_16x16x32_bf16 v[88:91], v[220:223], v[180:183], v[88:91]
    buffer_load_dwordx4 v[132:135], v2, s[40:43], s12 offen offset:1024 sc1
    s_waitcnt lgkmcnt(4)
    v_mfma_f32_16x16x32_bf16 v[52:55], v[200:203], v[176:179], v[52:55]
    ds_read_b128 v[220:223], v22 offset:3072
    v_mfma_f32_16x16x32_bf16 v[92:95], v[200:203], v[180:183], v[92:95]
    s_waitcnt lgkmcnt(4)
    v_mfma_f32_16x16x32_bf16 v[56:59], v[204:207], v[176:179], v[56:59]
    ds_read_b128 v[200:203], v22 offset:4096
    v_mfma_f32_16x16x32_bf16 v[96:99], v[204:207], v[180:183], v[96:99]
    ds_read_b128 v[32:35], v27
    s_waitcnt vmcnt(6)
    s_waitcnt lgkmcnt(5)
    v_mfma_f32_16x16x32_bf16 v[40:43], v[208:211], v[184:187], v[40:43]
    ds_read_b128 v[204:207], v23 offset:0
    v_mfma_f32_16x16x32_bf16 v[80:83], v[208:211], v[188:191], v[80:83]
    buffer_load_dwordx4 v[136:139], v2, s[40:43], s11 offen offset:2048 sc1
    s_waitcnt lgkmcnt(5)
    v_mfma_f32_16x16x32_bf16 v[44:47], v[212:215], v[184:187], v[44:47]
    ds_read_b128 v[208:211], v23 offset:1024
    v_mfma_f32_16x16x32_bf16 v[84:87], v[212:215], v[188:191], v[84:87]
    s_waitcnt lgkmcnt(5)
    v_mfma_f32_16x16x32_bf16 v[48:51], v[216:219], v[184:187], v[48:51]
    ds_read_b128 v[212:215], v23 offset:2048
    v_mfma_f32_16x16x32_bf16 v[88:91], v[216:219], v[188:191], v[88:91]
    buffer_load_dwordx4 v[140:143], v2, s[40:43], s12 offen offset:2048 sc1
    s_waitcnt lgkmcnt(5)
    v_mfma_f32_16x16x32_bf16 v[52:55], v[220:223], v[184:187], v[52:55]
    ds_read_b128 v[216:219], v23 offset:3072
    v_mfma_f32_16x16x32_bf16 v[92:95], v[220:223], v[188:191], v[92:95]
    s_waitcnt lgkmcnt(5)
    v_mfma_f32_16x16x32_bf16 v[56:59], v[200:203], v[184:187], v[56:59]
    ds_read_b128 v[220:223], v23 offset:4096
    v_mfma_f32_16x16x32_bf16 v[96:99], v[200:203], v[188:191], v[96:99]
    v_min_u32 v32, v32, v34
    v_cmp_gt_u32 vcc, 5, v32
    s_nop 1
    s_cmp_lg_u64 vcc, 0
    s_cbranch_scc1 L_gslow_22
L_gok_23:
    s_waitcnt vmcnt(6)
    s_waitcnt lgkmcnt(4)
    v_mfma_f32_16x16x32_bf16 v[40:43], v[204:207], v[192:195], v[40:43]
    ds_read_b128 v[200:203], v14 offset:0
    v_mfma_f32_16x16x32_bf16 v[80:83], v[204:207], v[196:199], v[80:83]
    buffer_load_dwordx4 v[144:147], v2, s[40:43], s11 offen offset:3072 sc1
    s_waitcnt lgkmcnt(4)
    v_mfma_f32_16x16x32_bf16 v[44:47], v[208:211], v[192:195], v[44:47]
    ds_read_b128 v[204:207], v14 offset:2048
    v_mfma_f32_16x16x32_bf16 v[84:87], v[208:211], v[196:199], v[84:87]
    s_waitcnt lgkmcnt(4)
    v_mfma_f32_16x16x32_bf16 v[48:51], v[212:215], v[192:195], v[48:51]
    ds_read_b128 v[208:211], v14 offset:4096
    v_mfma_f32_16x16x32_bf16 v[88:91], v[212:215], v[196:199], v[88:91]
    buffer_load_dwordx4 v[148:151], v2, s[40:43], s12 offen offset:3072 sc1
    s_waitcnt lgkmcnt(4)
    v_mfma_f32_16x16x32_bf16 v[52:55], v[216:219], v[192:195], v[52:55]
    ds_read_b128 v[212:215], v14 offset:6144
    v_mfma_f32_16x16x32_bf16 v[92:95], v[216:219], v[196:199], v[92:95]
    s_waitcnt lgkmcnt(4)
    v_mfma_f32_16x16x32_bf16 v[56:59], v[220:223], v[192:195], v[56:59]
    ds_read_b128 v[216:219], v14 offset:8192
    v_mfma_f32_16x16x32_bf16 v[96:99], v[220:223], v[196:199], v[96:99]
    s_waitcnt vmcnt(6)
    s_waitcnt lgkmcnt(4)
    v_mfma_f32_16x16x32_bf16 v[40:43], v[200:203], v[120:123], v[40:43]
    ds_read_b128 v[220:223], v15 offset:0
    v_mfma_f32_16x16x32_bf16 v[80:83], v[200:203], v[124:127], v[80:83]
    v_mul_u32_u24 v38, 80000, v11
    s_waitcnt lgkmcnt(4)
    v_mfma_f32_16x16x32_bf16 v[44:47], v[204:207], v[120:123], v[44:47]
    ds_read_b128 v[200:203], v15 offset:2048
    v_mfma_f32_16x16x32_bf16 v[84:87], v[204:207], v[124:127], v[84:87]
    v_sub_u32 v18, v18, v38
    s_waitcnt lgkmcnt(4)
    v_mfma_f32_16x16x32_bf16 v[48:51], v[208:211], v[120:123], v[48:51]
    ds_read_b128 v[204:207], v15 offset:4096
    v_mfma_f32_16x16x32_bf16 v[88:91], v[208:211], v[124:127], v[88:91]
    v_sub_u32 v19, v19, v38
    s_waitcnt lgkmcnt(4)
    v_mfma_f32_16x16x32_bf16 v[52:55], v[212:215], v[120:123], v[52:55]
    ds_read_b128 v[208:211], v15 offset:6144
    v_mfma_f32_16x16x32_bf16 v[92:95], v[212:215], v[124:127], v[92:95]
    v_sub_u32 v20, v20, v38
    s_waitcnt lgkmcnt(4)
    v_mfma_f32_16x16x32_bf16 v[56:59], v[216:219], v[120:123], v[56:59]
    ds_read_b128 v[212:215], v15 offset:8192
    v_mfma_f32_16x16x32_bf16 v[96:99], v[216:219], v[124:127], v[96:99]
    v_sub_u32 v21, v21, v38
    s_waitcnt vmcnt(4)
    s_waitcnt lgkmcnt(4)
    v_mfma_f32_16x16x32_bf16 v[40:43], v[220:223], v[128:131], v[40:43]
    ds_read_b128 v[216:219], v16 offset:0
    v_mfma_f32_16x16x32_bf16 v[80:83], v[220:223], v[132:135], v[80:83]
    s_waitcnt lgkmcnt(4)
    v_mfma_f32_16x16x32_bf16 v[44:47], v[200:203], v[128:131], v[44:47]
    ds_read_b128 v[220:223], v16 offset:2048
    v_mfma_f32_16x16x32_bf16 v[84:87], v[200:203], v[132:135], v[84:87]
    s_waitcnt lgkmcnt(4)
    v_mfma_f32_16x16x32_bf16 v[48:51], v[204:207], v[128:131], v[48:51]
    ds_read_b128 v[200:203], v16 offset:4096
    v_mfma_f32_16x16x32_bf16 v[88:91], v[204:207], v[132:135], v[88:91]
    s_waitcnt lgkmcnt(4)
    v_mfma_f32_16x16x32_bf16 v[52:55], v[208:211], v[128:131], v[52:55]
    ds_read_b128 v[204:207], v16 offset:6144
    v_mfma_f32_16x16x32_bf16 v[92:95], v[208:211], v[132:135], v[92:95]
    s_waitcnt lgkmcnt(4)
    v_mfma_f32_16x16x32_bf16 v[56:59], v[212:215], v[128:131], v[56:59]
    ds_read_b128 v[208:211], v16 offset:8192
    v_mfma_f32_16x16x32_bf16 v[96:99], v[212:215], v[132:135], v[96:99]
    s_waitcnt vmcnt(2)
    s_waitcnt lgkmcnt(4)
    v_mfma_f32_16x16x32_bf16 v[40:43], v[216:219], v[136:139], v[40:43]
    ds_read_b128 v[212:215], v17 offset:0
    v_mfma_f32_16x16x32_bf16 v[80:83], v[216:219], v[140:143], v[80:83]
    s_waitcnt lgkmcnt(4)
    v_mfma_f32_16x16x32_bf16 v[44:47], v[220:223], v[136:139], v[44:47]
    ds_read_b128 v[216:219], v17 offset:2048
    v_mfma_f32_16x16x32_bf16 v[84:87], v[220:223], v[140:143], v[84:87]
    s_waitcnt lgkmcnt(4)
    v_mfma_f32_16x16x32_bf16 v[48:51], v[200:203], v[136:139], v[48:51]
    ds_read_b128 v[220:223], v17 offset:4096
    v_mfma_f32_16x16x32_bf16 v[88:91], v[200:203], v[140:143], v[88:91]
    s_waitcnt lgkmcnt(4)
    v_mfma_f32_16x16x32_bf16 v[52:55], v[204:207], v[136:139], v[52:55]
    ds_read_b128 v[200:203], v17 offset:6144
    v_mfma_f32_16x16x32_bf16 v[92:95], v[204:207], v[140:143], v[92:95]
    s_waitcnt lgkmcnt(4)
    v_mfma_f32_16x16x32_bf16 v[56:59], v[208:211], v[136:139], v[56:59]
    ds_read_b128 v[204:207], v17 offset:8192
    v_mfma_f32_16x16x32_bf16 v[96:99], v[208:211], v[140:143], v[96:99]
    s_waitcnt vmcnt(0)
    s_waitcnt lgkmcnt(4)
    v_mfma_f32_16x16x32_bf16 v[40:43], v[212:215], v[144:147], v[40:43]
    ds_read_b128 v[208:211], v18 offset:10240
    v_mfma_f32_16x16x32_bf16 v[80:83], v[212:215], v[148:151], v[80:83]
    s_waitcnt lgkmcnt(4)
    v_mfma_f32_16x16x32_bf16 v[44:47], v[216:219], v[144:147], v[44:47]
    ds_read_b128 v[212:215], v18 offset:12288
    v_mfma_f32_16x16x32_bf16 v[84:87], v[216:219], v[148:151], v[84:87]
    s_waitcnt lgkmcnt(4)
    v_mfma_f32_16x16x32_bf16 v[48:51], v[220:223], v[144:147], v[48:51]
    ds_read_b128 v[216:219], v18 offset:14336
    v_mfma_f32_16x16x32_bf16 v[88:91], v[220:223], v[148:151], v[88:91]
    s_waitcnt lgkmcnt(4)
    v_mfma_f32_16x16x32_bf16 v[52:55], v[200:203], v[144:147], v[52:55]
    ds_read_b128 v[220:223], v18 offset:16384
    v_mfma_f32_16x16x32_bf16 v[92:95], v[200:203], v[148:151], v[92:95]
    s_waitcnt lgkmcnt(4)
    v_mfma_f32_16x16x32_bf16 v[56:59], v[204:207], v[144:147], v[56:59]
    ds_read_b128 v[200:203], v18 offset:18432
    v_mfma_f32_16x16x32_bf16 v[96:99], v[204:207], v[148:151], v[96:99]
    s_waitcnt lgkmcnt(4)
    v_mfma_f32_16x16x32_bf16 v[60:63], v[208:211], v[152:155], v[60:63]
    ds_read_b128 v[204:207], v19 offset:10240
    v_mfma_f32_16x16x32_bf16 v[100:103], v[208:211], v[156:159], v[100:103]
    v_mul_u32_u24 v38, 108800, v11
    s_waitcnt lgkmcnt(4)
    v_mfma_f32_16x16x32_bf16 v[64:67], v[212:215], v[152:155], v[64:67]
    ds_read_b128 v[208:211], v19 offset:12288
    v_mfma_f32_16x16x32_bf16 v[104:107], v[212:215], v[156:159], v[104:107]
    v_sub_u32 v14, v14, v38
    s_waitcnt lgkmcnt(4)
    v_mfma_f32_16x16x32_bf16 v[68:71], v[216:219], v[152:155], v[68:71]
    ds_read_b128 v[212:215], v19 offset:14336
    v_mfma_f32_16x16x32_bf16 v[108:111], v[216:219], v[156:159], v[108:111]
    v_sub_u32 v15, v15, v38
    s_waitcnt lgkmcnt(4)
    v_mfma_f32_16x16x32_bf16 v[72:75], v[220:223], v[152:155], v[72:75]
    ds_read_b128 v[216:219], v19 offset:16384
    v_mfma_f32_16x16x32_bf16 v[112:115], v[220:223], v[156:159], v[112:115]
    v_sub_u32 v16, v16, v38
    s_waitcnt lgkmcnt(4)
    v_mfma_f32_16x16x32_bf16 v[76:79], v[200:203], v[152:155], v[76:79]
    ds_read_b128 v[220:223], v19 offset:18432
    v_mfma_f32_16x16x32_bf16 v[116:119], v[200:203], v[156:159], v[116:119]
    v_sub_u32 v17, v17, v38
    s_waitcnt lgkmcnt(4)
    v_mfma_f32_16x16x32_bf16 v[60:63], v[204:207], v[160:163], v[60:63]
    ds_read_b128 v[200:203], v20 offset:10240
    v_mfma_f32_16x16x32_bf16 v[100:103], v[204:207], v[164:167], v[100:103]
    s_xor_b32 s23, s46, 3
    s_mul_i32 s23, s23, 40960
    s_add_u32 s23, s23, s32
    s_add_u32 s23, s23, 30720
    s_waitcnt lgkmcnt(4)
    v_mfma_f32_16x16x32_bf16 v[64:67], v[208:211], v[160:163], v[64:67]
    ds_read_b128 v[204:207], v20 offset:12288
    v_mfma_f32_16x16x32_bf16 v[104:107], v[208:211], v[164:167], v[104:107]
    v_cvt_pk_bf16_f32 v40, v40, v41
    v_cvt_pk_bf16_f32 v41, v42, v43
    v_cvt_pk_bf16_f32 v42, v44, v45
    s_waitcnt lgkmcnt(4)
    v_mfma_f32_16x16x32_bf16 v[68:71], v[212:215], v[160:163], v[68:71]
    ds_read_b128 v[208:211], v20 offset:14336
    v_mfma_f32_16x16x32_bf16 v[108:111], v[212:215], v[164:167], v[108:111]
    v_cvt_pk_bf16_f32 v43, v46, v47
    buffer_store_dwordx4 v[40:43], v2, s[40:43], s23 offen offset:0 sc1
    v_cvt_pk_bf16_f32 v44, v48, v49
    v_cvt_pk_bf16_f32 v45, v50, v51
    s_waitcnt lgkmcnt(4)
    v_mfma_f32_16x16x32_bf16 v[72:75], v[216:219], v[160:163], v[72:75]
    ds_read_b128 v[212:215], v20 offset:16384
    v_mfma_f32_16x16x32_bf16 v[112:115], v[216:219], v[164:167], v[112:115]
    v_cvt_pk_bf16_f32 v46, v52, v53
    v_cvt_pk_bf16_f32 v47, v54, v55
    buffer_store_dwordx4 v[44:47], v2, s[40:43], s23 offen offset:1024 sc1
    s_waitcnt lgkmcnt(4)
    v_mfma_f32_16x16x32_bf16 v[76:79], v[220:223], v[160:163], v[76:79]
    ds_read_b128 v[216:219], v20 offset:18432
    v_mfma_f32_16x16x32_bf16 v[116:119], v[220:223], v[164:167], v[116:119]
    v_cvt_pk_bf16_f32 v48, v56, v57
    v_cvt_pk_bf16_f32 v49, v58, v59
    buffer_store_dwordx2 v[48:49], v8, s[40:43], s23 offen offset:2048 sc1
    s_waitcnt lgkmcnt(4)
    v_mfma_f32_16x16x32_bf16 v[60:63], v[200:203], v[168:171], v[60:63]
    ds_read_b128 v[220:223], v21 offset:10240
    v_mfma_f32_16x16x32_bf16 v[100:103], v[200:203], v[172:175], v[100:103]
    s_xor_b32 s23, s46, 1
    s_mul_i32 s23, s23, 40960
    s_add_u32 s23, s23, s32
    s_add_u32 s23, s23, 10240
    s_waitcnt lgkmcnt(4)
    v_mfma_f32_16x16x32_bf16 v[64:67], v[204:207], v[168:171], v[64:67]
    ds_read_b128 v[200:203], v21 offset:12288
    v_mfma_f32_16x16x32_bf16 v[104:107], v[204:207], v[172:175], v[104:107]
    v_cvt_pk_bf16_f32 v80, v80, v81
    v_cvt_pk_bf16_f32 v81, v82, v83
    v_cvt_pk_bf16_f32 v82, v84, v85
    s_waitcnt lgkmcnt(4)
    v_mfma_f32_16x16x32_bf16 v[68:71], v[208:211], v[168:171], v[68:71]
    ds_read_b128 v[204:207], v21 offset:14336
    v_mfma_f32_16x16x32_bf16 v[108:111], v[208:211], v[172:175], v[108:111]
    v_cvt_pk_bf16_f32 v83, v86, v87
    buffer_store_dwordx4 v[80:83], v2, s[40:43], s23 offen offset:0 sc1
    v_cvt_pk_bf16_f32 v84, v88, v89
    v_cvt_pk_bf16_f32 v85, v90, v91
    s_waitcnt lgkmcnt(4)
    v_mfma_f32_16x16x32_bf16 v[72:75], v[212:215], v[168:171], v[72:75]
    ds_read_b128 v[208:211], v21 offset:16384
    v_mfma_f32_16x16x32_bf16 v[112:115], v[212:215], v[172:175], v[112:115]
    v_cvt_pk_bf16_f32 v86, v92, v93
    v_cvt_pk_bf16_f32 v87, v94, v95
    buffer_store_dwordx4 v[84:87], v2, s[40:43], s23 offen offset:1024 sc1
    s_waitcnt lgkmcnt(4)
    v_mfma_f32_16x16x32_bf16 v[76:79], v[216:219], v[168:171], v[76:79]
    ds_read_b128 v[212:215], v21 offset:18432
    v_mfma_f32_16x16x32_bf16 v[116:119], v[216:219], v[172:175], v[116:119]
    v_cvt_pk_bf16_f32 v88, v96, v97
    v_cvt_pk_bf16_f32 v89, v98, v99
    buffer_store_dwordx2 v[88:89], v8, s[40:43], s23 offen offset:2048 sc1
    s_waitcnt lgkmcnt(4)
    v_mfma_f32_16x16x32_bf16 v[60:63], v[220:223], v[176:179], v[60:63]
    ds_read_b128 v[216:219], v22 offset:5120
    v_mfma_f32_16x16x32_bf16 v[100:103], v[220:223], v[180:183], v[100:103]
    global_load_dwordx2 v[164:165], v13, s[20:21]
    global_load_dwordx2 v[166:167], v13, s[30:31]
    buffer_load_dwordx2 v[152:153], v12, s[56:59], s68 offen
    s_waitcnt lgkmcnt(4)
    v_mfma_f32_16x16x32_bf16 v[64:67], v[200:203], v[176:179], v[64:67]
    ds_read_b128 v[220:223], v22 offset:6144
    v_mfma_f32_16x16x32_bf16 v[104:107], v[200:203], v[180:183], v[104:107]
    s_add_u32 s68, s68, 3840
    buffer_load_dwordx2 v[154:155], v12, s[56:59], s68 offen
    s_add_u32 s68, s68, 3840
    s_waitcnt lgkmcnt(4)
    v_mfma_f32_16x16x32_bf16 v[68:71], v[204:207], v[176:179], v[68:71]
    ds_read_b128 v[200:203], v22 offset:7168
    v_mfma_f32_16x16x32_bf16 v[108:111], v[204:207], v[180:183], v[108:111]
    buffer_load_dwordx2 v[156:157], v12, s[56:59], s68 offen
    s_add_u32 s68, s68, 3840
    s_waitcnt lgkmcnt(4)
    v_mfma_f32_16x16x32_bf16 v[72:75], v[208:211], v[176:179], v[72:75]
    ds_read_b128 v[204:207], v22 offset:8192
    v_mfma_f32_16x16x32_bf16 v[112:115], v[208:211], v[180:183], v[112:115]
    buffer_load_dwordx2 v[158:159], v12, s[56:59], s68 offen
    s_add_u32 s68, s68, 3840
    buffer_load_dwordx2 v[160:161], v12, s[56:59], s68 offen
    s_waitcnt lgkmcnt(4)
    v_mfma_f32_16x16x32_bf16 v[76:79], v[212:215], v[176:179], v[76:79]
    ds_read_b128 v[208:211], v22 offset:9216
    v_mfma_f32_16x16x32_bf16 v[116:119], v[212:215], v[180:183], v[116:119]
    s_add_u32 s68, s68, 3840
    buffer_load_dwordx2 v[162:163], v12, s[56:59], s68 offen
    ds_read_b128 v[32:35], v27
    s_waitcnt lgkmcnt(5)
    v_mfma_f32_16x16x32_bf16 v[60:63], v[216:219], v[184:187], v[60:63]
    ds_read_b128 v[212:215], v23 offset:5120
    v_mfma_f32_16x16x32_bf16 v[100:103], v[216:219], v[188:191], v[100:103]
    s_waitcnt lgkmcnt(5)
    v_mfma_f32_16x16x32_bf16 v[64:67], v[220:223], v[184:187], v[64:67]
    ds_read_b128 v[216:219], v23 offset:6144
    v_mfma_f32_16x16x32_bf16 v[104:107], v[220:223], v[188:191], v[104:107]
    s_waitcnt lgkmcnt(5)
    v_mfma_f32_16x16x32_bf16 v[68:71], v[200:203], v[184:187], v[68:71]
    ds_read_b128 v[220:223], v23 offset:7168
    v_mfma_f32_16x16x32_bf16 v[108:111], v[200:203], v[188:191], v[108:111]
    s_waitcnt lgkmcnt(5)
    v_mfma_f32_16x16x32_bf16 v[72:75], v[204:207], v[184:187], v[72:75]
    ds_read_b128 v[200:203], v23 offset:8192
    v_mfma_f32_16x16x32_bf16 v[112:115], v[204:207], v[188:191], v[112:115]
    s_waitcnt lgkmcnt(5)
    v_mfma_f32_16x16x32_bf16 v[76:79], v[208:211], v[184:187], v[76:79]
    ds_read_b128 v[204:207], v23 offset:9216
    v_mfma_f32_16x16x32_bf16 v[116:119], v[208:211], v[188:191], v[116:119]
    v_min3_u32 v32, v32, v33, v34
    v_min_u32 v32, v32, v35
    v_cmp_gt_u32 vcc, 5, v32
    s_nop 1
    s_cmp_lg_u64 vcc, 0
    s_cbranch_scc1 L_gslow_25
L_gok_26:
    s_waitcnt lgkmcnt(4)
    v_mfma_f32_16x16x32_bf16 v[60:63], v[212:215], v[192:195], v[60:63]
    ds_read_b128 v[208:211], v14 offset:10240
    s_waitcnt lgkmcnt(4)
    v_mfma_f32_16x16x32_bf16 v[64:67], v[216:219], v[192:195], v[64:67]
    ds_read_b128 v[212:215], v14 offset:12288
    s_waitcnt lgkmcnt(4)
    v_mfma_f32_16x16x32_bf16 v[68:71], v[220:223], v[192:195], v[68:71]
    ds_read_b128 v[216:219], v14 offset:14336
    s_waitcnt lgkmcnt(4)
    v_mfma_f32_16x16x32_bf16 v[72:75], v[200:203], v[192:195], v[72:75]
    ds_read_b128 v[220:223], v14 offset:16384
    s_waitcnt lgkmcnt(4)
    v_mfma_f32_16x16x32_bf16 v[76:79], v[204:207], v[192:195], v[76:79]
    ds_read_b128 v[200:203], v14 offset:18432
    s_waitcnt lgkmcnt(4)
    v_mfma_f32_16x16x32_bf16 v[60:63], v[208:211], v[120:123], v[60:63]
    ds_read_b128 v[204:207], v15 offset:10240
    s_waitcnt lgkmcnt(4)
    v_mfma_f32_16x16x32_bf16 v[64:67], v[212:215], v[120:123], v[64:67]
    ds_read_b128 v[208:211], v15 offset:12288
    s_waitcnt lgkmcnt(4)
    v_mfma_f32_16x16x32_bf16 v[68:71], v[216:219], v[120:123], v[68:71]
    ds_read_b128 v[212:215], v15 offset:14336
    s_waitcnt lgkmcnt(4)
    v_mfma_f32_16x16x32_bf16 v[72:75], v[220:223], v[120:123], v[72:75]
    ds_read_b128 v[216:219], v15 offset:16384
    s_waitcnt lgkmcnt(4)
    v_mfma_f32_16x16x32_bf16 v[76:79], v[200:203], v[120:123], v[76:79]
    ds_read_b128 v[220:223], v15 offset:18432
    s_waitcnt lgkmcnt(4)
    v_mfma_f32_16x16x32_bf16 v[60:63], v[204:207], v[128:131], v[60:63]
    ds_read_b128 v[200:203], v16 offset:10240
    s_waitcnt lgkmcnt(4)
    v_mfma_f32_16x16x32_bf16 v[64:67], v[208:211], v[128:131], v[64:67]
    ds_read_b128 v[204:207], v16 offset:12288
    s_waitcnt lgkmcnt(4)
    v_mfma_f32_16x16x32_bf16 v[68:71], v[212:215], v[128:131], v[68:71]
    ds_read_b128 v[208:211], v16 offset:14336
    s_waitcnt lgkmcnt(4)
    v_mfma_f32_16x16x32_bf16 v[72:75], v[216:219], v[128:131], v[72:75]
    ds_read_b128 v[212:215], v16 offset:16384
    s_waitcnt lgkmcnt(4)
    v_mfma_f32_16x16x32_bf16 v[76:79], v[220:223], v[128:131], v[76:79]
    ds_read_b128 v[216:219], v16 offset:18432
    s_waitcnt lgkmcnt(4)
    v_mfma_f32_16x16x32_bf16 v[60:63], v[200:203], v[136:139], v[60:63]
    ds_read_b128 v[220:223], v17 offset:10240
    s_waitcnt lgkmcnt(4)
    v_mfma_f32_16x16x32_bf16 v[64:67], v[204:207], v[136:139], v[64:67]
    ds_read_b128 v[200:203], v17 offset:12288
    s_waitcnt lgkmcnt(4)
    v_mfma_f32_16x16x32_bf16 v[68:71], v[208:211], v[136:139], v[68:71]
    ds_read_b128 v[204:207], v17 offset:14336
    s_waitcnt lgkmcnt(4)
    v_mfma_f32_16x16x32_bf16 v[72:75], v[212:215], v[136:139], v[72:75]
    ds_read_b128 v[208:211], v17 offset:16384
    s_waitcnt lgkmcnt(4)
    v_mfma_f32_16x16x32_bf16 v[76:79], v[216:219], v[136:139], v[76:79]
    ds_read_b128 v[212:215], v17 offset:18432
    s_waitcnt lgkmcnt(4)
    v_mfma_f32_16x16x32_bf16 v[60:63], v[220:223], v[144:147], v[60:63]
    ds_read_b128 v[216:219], v23 offset:5120
    s_waitcnt lgkmcnt(4)
    v_mfma_f32_16x16x32_bf16 v[64:67], v[200:203], v[144:147], v[64:67]
    ds_read_b128 v[220:223], v23 offset:6144
    s_waitcnt lgkmcnt(4)
    v_mfma_f32_16x16x32_bf16 v[68:71], v[204:207], v[144:147], v[68:71]
    ds_read_b128 v[200:203], v23 offset:7168
    s_waitcnt lgkmcnt(4)
    v_mfma_f32_16x16x32_bf16 v[72:75], v[208:211], v[144:147], v[72:75]
    ds_read_b128 v[204:207], v23 offset:8192
    s_waitcnt lgkmcnt(4)
    v_mfma_f32_16x16x32_bf16 v[76:79], v[212:215], v[144:147], v[76:79]
    ds_read_b128 v[208:211], v23 offset:9216
    s_waitcnt vmcnt(8)
    s_mov_b64 exec, 1
    buffer_store_dword v36, off, s[40:43], s18 sc1
    s_mov_b64 exec, -1
    s_waitcnt lgkmcnt(4)
    v_mfma_f32_16x16x32_bf16 v[100:103], v[216:219], v[196:199], v[100:103]
    ds_read_b128 v[212:215], v14 offset:10240
    s_xor_b32 s23, s46, 2
    s_mul_i32 s23, s23, 40960
    s_waitcnt lgkmcnt(4)
    v_mfma_f32_16x16x32_bf16 v[104:107], v[220:223], v[196:199], v[104:107]
    ds_read_b128 v[216:219], v14 offset:12288
    s_add_u32 s23, s23, s32
    s_add_u32 s23, s23, 20480
    s_waitcnt lgkmcnt(4)
    v_mfma_f32_16x16x32_bf16 v[108:111], v[200:203], v[196:199], v[108:111]
    ds_read_b128 v[220:223], v14 offset:14336
    v_cvt_pk_bf16_f32 v60, v60, v61
    v_cvt_pk_bf16_f32 v61, v62, v63
    s_waitcnt lgkmcnt(4)
    v_mfma_f32_16x16x32_bf16 v[112:115], v[204:207], v[196:199], v[112:115]
    ds_read_b128 v[200:203], v14 offset:16384
    v_cvt_pk_bf16_f32 v62, v64, v65
    v_cvt_pk_bf16_f32 v63, v66, v67
    s_waitcnt lgkmcnt(4)
    v_mfma_f32_16x16x32_bf16 v[116:119], v[208:211], v[196:199], v[116:119]
    ds_read_b128 v[204:207], v14 offset:18432
    buffer_store_dwordx4 v[60:63], v2, s[40:43], s23 offen offset:0 sc1
    v_cvt_pk_bf16_f32 v64, v68, v69
    s_waitcnt lgkmcnt(4)
    v_mfma_f32_16x16x32_bf16 v[100:103], v[212:215], v[124:127], v[100:103]
    ds_read_b128 v[208:211], v15 offset:10240
    v_cvt_pk_bf16_f32 v65, v70, v71
    v_cvt_pk_bf16_f32 v66, v72, v73
    s_waitcnt lgkmcnt(4)
    v_mfma_f32_16x16x32_bf16 v[104:107], v[216:219], v[124:127], v[104:107]
    ds_read_b128 v[212:215], v15 offset:12288
    v_cvt_pk_bf16_f32 v67, v74, v75
    buffer_store_dwordx4 v[64:67], v2, s[40:43], s23 offen offset:1024 sc1
    s_waitcnt lgkmcnt(4)
    v_mfma_f32_16x16x32_bf16 v[108:111], v[220:223], v[124:127], v[108:111]
    ds_read_b128 v[216:219], v15 offset:14336
    v_cvt_pk_bf16_f32 v68, v76, v77
    v_cvt_pk_bf16_f32 v69, v78, v79
    s_waitcnt lgkmcnt(4)
    v_mfma_f32_16x16x32_bf16 v[112:115], v[200:203], v[124:127], v[112:115]
    ds_read_b128 v[220:223], v15 offset:16384
    buffer_store_dwordx2 v[68:69], v8, s[40:43], s23 offen offset:2048 sc1
    s_waitcnt lgkmcnt(4)
    v_mfma_f32_16x16x32_bf16 v[116:119], v[204:207], v[124:127], v[116:119]
    ds_read_b128 v[200:203], v15 offset:18432
    s_waitcnt lgkmcnt(4)
    v_mfma_f32_16x16x32_bf16 v[100:103], v[208:211], v[132:135], v[100:103]
    ds_read_b128 v[204:207], v16 offset:10240
    s_waitcnt lgkmcnt(4)
    v_mfma_f32_16x16x32_bf16 v[104:107], v[212:215], v[132:135], v[104:107]
    ds_read_b128 v[208:211], v16 offset:12288
    s_waitcnt lgkmcnt(4)
    v_mfma_f32_16x16x32_bf16 v[108:111], v[216:219], v[132:135], v[108:111]
    ds_read_b128 v[212:215], v16 offset:14336
    s_waitcnt lgkmcnt(4)
    v_mfma_f32_16x16x32_bf16 v[112:115], v[220:223], v[132:135], v[112:115]
    ds_read_b128 v[216:219], v16 offset:16384
    s_waitcnt lgkmcnt(4)
    v_mfma_f32_16x16x32_bf16 v[116:119], v[200:203], v[132:135], v[116:119]
    ds_read_b128 v[220:223], v16 offset:18432
    s_waitcnt lgkmcnt(4)
    v_mfma_f32_16x16x32_bf16 v[100:103], v[204:207], v[140:143], v[100:103]
    ds_read_b128 v[200:203], v17 offset:10240
    s_waitcnt lgkmcnt(4)
    v_mfma_f32_16x16x32_bf16 v[104:107], v[208:211], v[140:143], v[104:107]
    ds_read_b128 v[204:207], v17 offset:12288
    s_waitcnt lgkmcnt(4)
    v_mfma_f32_16x16x32_bf16 v[108:111], v[212:215], v[140:143], v[108:111]
    ds_read_b128 v[208:211], v17 offset:14336
    s_waitcnt lgkmcnt(4)
    v_mfma_f32_16x16x32_bf16 v[112:115], v[216:219], v[140:143], v[112:115]
    ds_read_b128 v[212:215], v17 offset:16384
    s_waitcnt lgkmcnt(4)
    v_mfma_f32_16x16x32_bf16 v[116:119], v[220:223], v[140:143], v[116:119]
    ds_read_b128 v[216:219], v17 offset:18432
    s_waitcnt lgkmcnt(4)
    v_mfma_f32_16x16x32_bf16 v[100:103], v[200:203], v[148:151], v[100:103]
    s_waitcnt lgkmcnt(3)
    v_mfma_f32_16x16x32_bf16 v[104:107], v[204:207], v[148:151], v[104:107]
    s_waitcnt lgkmcnt(2)
    v_mfma_f32_16x16x32_bf16 v[108:111], v[208:211], v[148:151], v[108:111]
    s_waitcnt lgkmcnt(1)
    v_mfma_f32_16x16x32_bf16 v[112:115], v[212:215], v[148:151], v[112:115]
    s_waitcnt lgkmcnt(0)
    v_mfma_f32_16x16x32_bf16 v[116:119], v[216:219], v[148:151], v[116:119]
    s_setprio 2
    s_add_u32 s18, s18, 512
    s_waitcnt vmcnt(0)
    s_mov_b64 exec, 1
    buffer_store_dword v36, off, s[40:43], s18 sc1
    s_mov_b64 exec, -1
    s_lshl_b32 s50, s17, 6
    s_add_u32 s50, s50, 156928
    v_lshl_add_u32 v38, v4, 2, s50
    ds_read_b32 v34, v38 offset:0
    ds_read_b32 v35, v38 offset:12
    ds_read_b32 v26, v38 offset:24
    ds_read_b32 v31, v38 offset:36
    ds_read_b32 v32, v38 offset:48
    ds_read_b32 v33, v38 offset:60
    s_waitcnt vmcnt(5)
    v_lshlrev_b32 v248, 16, v164
    v_and_b32 v249, v37, v164
    v_lshlrev_b32 v250, 16, v165
    v_and_b32 v251, v37, v165
    v_lshlrev_b32 v252, 16, v166
    v_and_b32 v253, v37, v166
    v_lshlrev_b32 v254, 16, v167
    v_and_b32 v255, v37, v167
    s_waitcnt lgkmcnt(0)
    v_lshlrev_b32 v224, 16, v152
    v_and_b32 v225, v37, v152
    v_lshlrev_b32 v226, 16, v153
    v_and_b32 v227, v37, v153
    v_pk_fma_f32 v[224:225], v[224:225], v[248:249], v[252:253] neg_lo:[0,0,1] neg_hi:[0,0,1]
    v_pk_fma_f32 v[226:227], v[226:227], v[250:251], v[254:255] neg_lo:[0,0,1] neg_hi:[0,0,1]
    v_fma_f32 v224, v224, v34, v252
    v_fma_f32 v225, v225, v34, v253
    v_fma_f32 v226, v226, v34, v254
    v_fma_f32 v227, v227, v34, v255
    v_lshlrev_b32 v228, 16, v154
    v_and_b32 v229, v37, v154
    v_lshlrev_b32 v230, 16, v155
    v_and_b32 v231, v37, v155
    v_pk_fma_f32 v[228:229], v[228:229], v[248:249], v[252:253] neg_lo:[0,0,1] neg_hi:[0,0,1]
    v_pk_fma_f32 v[230:231], v[230:231], v[250:251], v[254:255] neg_lo:[0,0,1] neg_hi:[0,0,1]
    v_fma_f32 v228, v228, v35, v252
    v_fma_f32 v229, v229, v35, v253
    v_fma_f32 v230, v230, v35, v254
    v_fma_f32 v231, v231, v35, v255
    v_lshlrev_b32 v232, 16, v156
    v_and_b32 v233, v37, v156
    v_lshlrev_b32 v234, 16, v157
    v_and_b32 v235, v37, v157
    v_pk_fma_f32 v[232:233], v[232:233], v[248:249], v[252:253] neg_lo:[0,0,1] neg_hi:[0,0,1]
    v_pk_fma_f32 v[234:235], v[234:235], v[250:251], v[254:255] neg_lo:[0,0,1] neg_hi:[0,0,1]
    v_fma_f32 v232, v232, v26, v252
    v_fma_f32 v233, v233, v26, v253
    v_fma_f32 v234, v234, v26, v254
    v_fma_f32 v235, v235, v26, v255
    v_lshlrev_b32 v236, 16, v158
    v_and_b32 v237, v37, v158
    v_lshlrev_b32 v238, 16, v159
    v_and_b32 v239, v37, v159
    v_pk_fma_f32 v[236:237], v[236:237], v[248:249], v[252:253] neg_lo:[0,0,1] neg_hi:[0,0,1]
    v_pk_fma_f32 v[238:239], v[238:239], v[250:251], v[254:255] neg_lo:[0,0,1] neg_hi:[0,0,1]
    v_fma_f32 v236, v236, v31, v252
    v_fma_f32 v237, v237, v31, v253
    v_fma_f32 v238, v238, v31, v254
    v_fma_f32 v239, v239, v31, v255
    v_lshlrev_b32 v240, 16, v160
    v_and_b32 v241, v37, v160
    v_lshlrev_b32 v242, 16, v161
    v_and_b32 v243, v37, v161
    v_pk_fma_f32 v[240:241], v[240:241], v[248:249], v[252:253] neg_lo:[0,0,1] neg_hi:[0,0,1]
    v_pk_fma_f32 v[242:243], v[242:243], v[250:251], v[254:255] neg_lo:[0,0,1] neg_hi:[0,0,1]
    v_fma_f32 v240, v240, v32, v252
    v_fma_f32 v241, v241, v32, v253
    v_fma_f32 v242, v242, v32, v254
    v_fma_f32 v243, v243, v32, v255
    v_lshlrev_b32 v244, 16, v162
    v_and_b32 v245, v37, v162
    v_lshlrev_b32 v246, 16, v163
    v_and_b32 v247, v37, v163
    v_pk_fma_f32 v[244:245], v[244:245], v[248:249], v[252:253] neg_lo:[0,0,1] neg_hi:[0,0,1]
    v_pk_fma_f32 v[246:247], v[246:247], v[250:251], v[254:255] neg_lo:[0,0,1] neg_hi:[0,0,1]
    v_fma_f32 v244, v244, v33, v252
    v_fma_f32 v245, v245, v33, v253
    v_fma_f32 v246, v246, v33, v254
    v_fma_f32 v247, v247, v33, v255
    s_mov_b64 exec, 15
    buffer_load_dword v30, v28, s[40:43], 0 offen sc1
    s_mov_b64 exec, -1
    s_waitcnt vmcnt(0)
    v_cmp_ne_u32 vcc, s49, v30
    s_nop 1
    s_and_b32 s53, vcc_lo, 10
    s_cbranch_scc1 L_slow_28
L_ok_29:
    s_add_u32 s50, s33, 30720
    buffer_load_dwordx4 v[168:171], v2, s[40:43], s50 offen sc1
    buffer_load_dwordx4 v[172:175], v2, s[40:43], s50 offen offset:1024 sc1
    buffer_load_dwordx2 v[176:177], v8, s[40:43], s50 offen offset:2048 sc1
    s_add_u32 s50, s33, 10240
    buffer_load_dwordx4 v[178:181], v2, s[40:43], s50 offen sc1
    buffer_load_dwordx4 v[182:185], v2, s[40:43], s50 offen offset:1024 sc1
    buffer_load_dwordx2 v[186:187], v8, s[40:43], s50 offen offset:2048 sc1
    v_cmp_ne_u32 vcc, s49, v30
    s_nop 1
    s_and_b32 s53, vcc_lo, 4
    s_cbranch_scc1 L_slow_31
L_ok_32:
    s_add_u32 s50, s33, 20480
    buffer_load_dwordx4 v[188:191], v2, s[40:43], s50 offen sc1
    buffer_load_dwordx4 v[192:195], v2, s[40:43], s50 offen offset:1024 sc1
    buffer_load_dwordx2 v[196:197], v8, s[40:43], s50 offen offset:2048 sc1
    s_waitcnt vmcnt(6)
    v_lshlrev_b32 v144, 16, v168
    v_and_b32 v145, v37, v168
    v_pk_add_f32 v[100:101], v[100:101], v[144:145]
    v_lshlrev_b32 v146, 16, v169
    v_and_b32 v147, v37, v169
    v_pk_add_f32 v[102:103], v[102:103], v[146:147]
    v_lshlrev_b32 v148, 16, v170
    v_and_b32 v149, v37, v170
    v_pk_add_f32 v[104:105], v[104:105], v[148:149]
    v_lshlrev_b32 v150, 16, v171
    v_and_b32 v151, v37, v171
    v_pk_add_f32 v[106:107], v[106:107], v[150:151]
    v_lshlrev_b32 v144, 16, v172
    v_and_b32 v145, v37, v172
    v_pk_add_f32 v[108:109], v[108:109], v[144:145]
    v_lshlrev_b32 v146, 16, v173
    v_and_b32 v147, v37, v173
    v_pk_add_f32 v[110:111], v[110:111], v[146:147]
    v_lshlrev_b32 v148, 16, v174
    v_and_b32 v149, v37, v174
    v_pk_add_f32 v[112:113], v[112:113], v[148:149]
    v_lshlrev_b32 v150, 16, v175
    v_and_b32 v151, v37, v175
    v_pk_add_f32 v[114:115], v[114:115], v[150:151]
    v_lshlrev_b32 v144, 16, v176
    v_and_b32 v145, v37, v176
    v_pk_add_f32 v[116:117], v[116:117], v[144:145]
    v_lshlrev_b32 v146, 16, v177
    v_and_b32 v147, v37, v177
    v_pk_add_f32 v[118:119], v[118:119], v[146:147]
    s_waitcnt vmcnt(3)
    v_lshlrev_b32 v144, 16, v178
    v_and_b32 v145, v37, v178
    v_pk_add_f32 v[100:101], v[100:101], v[144:145]
    v_lshlrev_b32 v146, 16, v179
    v_and_b32 v147, v37, v179
    v_pk_add_f32 v[102:103], v[102:103], v[146:147]
    v_lshlrev_b32 v148, 16, v180
    v_and_b32 v149, v37, v180
    v_pk_add_f32 v[104:105], v[104:105], v[148:149]
    v_lshlrev_b32 v150, 16, v181
    v_and_b32 v151, v37, v181
    v_pk_add_f32 v[106:107], v[106:107], v[150:151]
    v_lshlrev_b32 v144, 16, v182
    v_and_b32 v145, v37, v182
    v_pk_add_f32 v[108:109], v[108:109], v[144:145]
    v_lshlrev_b32 v146, 16, v183
    v_and_b32 v147, v37, v183
    v_pk_add_f32 v[110:111], v[110:111], v[146:147]
    v_lshlrev_b32 v148, 16, v184
    v_and_b32 v149, v37, v184
    v_pk_add_f32 v[112:113], v[112:113], v[148:149]
    v_lshlrev_b32 v150, 16, v185
    v_and_b32 v151, v37, v185
    v_pk_add_f32 v[114:115], v[114:115], v[150:151]
    v_lshlrev_b32 v144, 16, v186
    v_and_b32 v145, v37, v186
    v_pk_add_f32 v[116:117], v[116:117], v[144:145]
    v_lshlrev_b32 v146, 16, v187
    v_and_b32 v147, v37, v187
    v_pk_add_f32 v[118:119], v[118:119], v[146:147]
    s_waitcnt vmcnt(0)
    v_lshlrev_b32 v144, 16, v188
    v_and_b32 v145, v37, v188
    v_pk_add_f32 v[100:101], v[100:101], v[144:145]
    v_lshlrev_b32 v146, 16, v189
    v_and_b32 v147, v37, v189
    v_pk_add_f32 v[102:103], v[102:103], v[146:147]
    ds_write_b128 v9, v[100:103] offset:0
    v_lshlrev_b32 v148, 16, v190
    v_and_b32 v149, v37, v190
    v_pk_add_f32 v[104:105], v[104:105], v[148:149]
    v_lshlrev_b32 v150, 16, v191
    v_and_b32 v151, v37, v191
    v_pk_add_f32 v[106:107], v[106:107], v[150:151]
    ds_write_b128 v9, v[104:107] offset:64
    v_lshlrev_b32 v144, 16, v192
    v_and_b32 v145, v37, v192
    v_pk_add_f32 v[108:109], v[108:109], v[144:145]
    v_lshlrev_b32 v146, 16, v193
    v_and_b32 v147, v37, v193
    v_pk_add_f32 v[110:111], v[110:111], v[146:147]
    ds_write_b128 v9, v[108:111] offset:128
    v_lshlrev_b32 v148, 16, v194
    v_and_b32 v149, v37, v194
    v_pk_add_f32 v[112:113], v[112:113], v[148:149]
    v_lshlrev_b32 v150, 16, v195
    v_and_b32 v151, v37, v195
    v_pk_add_f32 v[114:115], v[114:115], v[150:151]
    ds_write_b128 v9, v[112:115] offset:192
    v_lshlrev_b32 v144, 16, v196
    v_and_b32 v145, v37, v196
    v_pk_add_f32 v[116:117], v[116:117], v[144:145]
    v_lshlrev_b32 v146, 16, v197
    v_and_b32 v147, v37, v197
    v_pk_add_f32 v[118:119], v[118:119], v[146:147]
    ds_write_b128 v9, v[116:119] offset:256
    ds_read_b128 v[120:123], v10 offset:0
    ds_read_b128 v[124:127], v10 offset:1008
    ds_read_b128 v[128:131], v10 offset:2016
    ds_read_b128 v[132:135], v10 offset:3024
    ds_read_b128 v[136:139], v10 offset:4032
    ds_read_b128 v[140:143], v10 offset:5040
    s_waitcnt lgkmcnt(5)
    v_pk_add_f32 v[224:225], v[224:225], v[120:121]
    v_pk_add_f32 v[226:227], v[226:227], v[122:123]
    buffer_store_dwordx4 v[224:227], v7, s[60:63], s69 offen sc1
    s_add_u32 s69, s69, 7680
    s_waitcnt lgkmcnt(4)
    v_pk_add_f32 v[228:229], v[228:229], v[124:125]
    v_pk_add_f32 v[230:231], v[230:231], v[126:127]
    buffer_store_dwordx4 v[228:231], v7, s[60:63], s69 offen sc1
    s_add_u32 s69, s69, 7680
    s_waitcnt lgkmcnt(3)
    v_pk_add_f32 v[232:233], v[232:233], v[128:129]
    v_pk_add_f32 v[234:235], v[234:235], v[130:131]
    buffer_store_dwordx4 v[232:235], v7, s[60:63], s69 offen sc1
    s_add_u32 s69, s69, 7680
    s_waitcnt lgkmcnt(2)
    v_pk_add_f32 v[236:237], v[236:237], v[132:133]
    v_pk_add_f32 v[238:239], v[238:239], v[134:135]
    buffer_store_dwordx4 v[236:239], v7, s[60:63], s69 offen sc1
    s_add_u32 s69, s69, 7680
    s_waitcnt lgkmcnt(1)
    v_pk_add_f32 v[240:241], v[240:241], v[136:137]
    v_pk_add_f32 v[242:243], v[242:243], v[138:139]
    buffer_store_dwordx4 v[240:243], v7, s[60:63], s69 offen sc1
    s_add_u32 s69, s69, 7680
    s_waitcnt lgkmcnt(0)
    v_pk_add_f32 v[244:245], v[244:245], v[140:141]
    v_pk_add_f32 v[246:247], v[246:247], v[142:143]
    buffer_store_dwordx4 v[244:247], v6, s[60:63], s69 offen sc1
    s_lshl_b32 s50, s45, 2
    s_add_u32 s50, s50, s48
    s_lshl_b32 s50, s50, 4
    s_add_u32 s50, s50, s44
    s_cmp_lg_u32 s50, 15
    s_cbranch_scc1 L_noep_34
    s_mov_b64 exec, 1
    buffer_store_dword v36, off, s[40:43], 0 sc1
    s_mov_b64 exec, -1
L_noep_34:
    s_endpgm
L_slow_1:
    s_mov_b32 s3, 16384
L_spin_3:
    s_mov_b64 exec, 15
    buffer_load_dword v30, v28, s[40:43], 0 offen sc1
    s_mov_b64 exec, -1
    s_sub_u32 s3, s3, 1
    s_cbranch_scc1 L_ok_2
    s_waitcnt vmcnt(0)
    v_cmp_ne_u32 vcc, s49, v30
    s_nop 1
    s_and_b32 s53, vcc_lo, s19
    s_cbranch_scc0 L_ok_2
    s_sleep 2
    s_branch L_spin_3
L_slow_4:
    s_mov_b32 s3, 16384
L_spin_6:
    s_mov_b64 exec, 15
    buffer_load_dword v30, v28, s[40:43], 0 offen sc1
    s_mov_b64 exec, -1
    s_sub_u32 s3, s3, 1
    s_cbranch_scc1 L_ok_5
    s_waitcnt vmcnt(0)
    v_cmp_ne_u32 vcc, s49, v30
    s_nop 1
    s_and_b32 s53, vcc_lo, s19
    s_cbranch_scc0 L_ok_5
    s_sleep 2
    s_branch L_spin_6
L_gslow_7:
    s_mov_b32 s3, 131072
L_gspin_9:
    ds_read_b128 v[32:35], v27 offset:16
    s_sub_u32 s3, s3, 1
    s_waitcnt lgkmcnt(0)
    s_cbranch_scc1 L_gok_8
    v_min3_u32 v32, v32, v33, v34
    v_min_u32 v32, v32, v35
    v_cmp_gt_u32 vcc, 5, v32
    s_nop 1
    s_cmp_lg_u64 vcc, 0
    s_cbranch_scc1 L_gspin_9
    s_branch L_gok_8
L_slow_10:
    s_mov_b32 s3, 16384
L_spin_12:
    s_mov_b64 exec, 15
    buffer_load_dword v30, v28, s[40:43], 0 offen sc1
    s_mov_b64 exec, -1
    s_sub_u32 s3, s3, 1
    s_cbranch_scc1 L_ok_11
    s_waitcnt vmcnt(0)
    v_cmp_ne_u32 vcc, s49, v30
    s_nop 1
    s_and_b32 s53, vcc_lo, s19
    s_cbranch_scc0 L_ok_11
    s_sleep 2
    s_branch L_spin_12
L_gslow_13:
    s_mov_b32 s3, 131072
L_gspin_15:
    ds_read_b128 v[32:35], v27 offset:0
    s_sub_u32 s3, s3, 1
    s_waitcnt lgkmcnt(0)
    s_cbranch_scc1 L_gok_14
    v_min3_u32 v32, v32, v33, v34
    v_min_u32 v32, v32, v35
    v_cmp_gt_u32 vcc, 1, v32
    s_nop 1
    s_cmp_lg_u64 vcc, 0
    s_cbranch_scc1 L_gspin_15
    s_branch L_gok_14
L_slow_16:
    s_mov_b32 s3, 16384
L_spin_18:
    s_mov_b64 exec, 15
    buffer_load_dword v31, v28, s[40:43], s18 offen sc1
    s_mov_b64 exec, -1
    s_sub_u32 s3, s3, 1
    s_cbranch_scc1 L_ok_17
    s_waitcnt vmcnt(0)
    v_cmp_ne_u32 vcc, s49, v31
    s_nop 1
    s_and_b32 s53, vcc_lo, 15
    s_cbranch_scc0 L_ok_17
    s_sleep 2
    s_branch L_spin_18
L_gslow_19:
    s_mov_b32 s3, 131072
L_gspin_21:
    ds_read_b128 v[32:35], v27 offset:0
    s_sub_u32 s3, s3, 1
    s_waitcnt lgkmcnt(0)
    s_cbranch_scc1 L_gok_20
    v_min3_u32 v32, v32, v33, v34
    v_min_u32 v32, v32, v35
    v_cmp_gt_u32 vcc, 4, v32
    s_nop 1
    s_cmp_lg_u64 vcc, 0
    s_cbranch_scc1 L_gspin_21
    s_branch L_gok_20
L_gslow_22:
    s_mov_b32 s3, 131072
L_gspin_24:
    ds_read_b128 v[32:35], v27 offset:0
    s_sub_u32 s3, s3, 1
    s_waitcnt lgkmcnt(0)
    s_cbranch_scc1 L_gok_23
    v_min_u32 v32, v32, v34
    v_cmp_gt_u32 vcc, 5, v32
    s_nop 1
    s_cmp_lg_u64 vcc, 0
    s_cbranch_scc1 L_gspin_24
    s_branch L_gok_23
L_gslow_25:
    s_mov_b32 s3, 131072
L_gspin_27:
    ds_read_b128 v[32:35], v27 offset:0
    s_sub_u32 s3, s3, 1
    s_waitcnt lgkmcnt(0)
    s_cbranch_scc1 L_gok_26
    v_min3_u32 v32, v32, v33, v34
    v_min_u32 v32, v32, v35
    v_cmp_gt_u32 vcc, 5, v32
    s_nop 1
    s_cmp_lg_u64 vcc, 0
    s_cbranch_scc1 L_gspin_27
    s_branch L_gok_26
L_slow_28:
    s_mov_b32 s3, 16384
L_spin_30:
    s_mov_b64 exec, 15
    buffer_load_dword v30, v28, s[40:43], 0 offen sc1
    s_mov_b64 exec, -1
    s_sub_u32 s3, s3, 1
    s_cbranch_scc1 L_ok_29
    s_waitcnt vmcnt(0)
    v_cmp_ne_u32 vcc, s49, v30
    s_nop 1
    s_and_b32 s53, vcc_lo, 10
    s_cbranch_scc0 L_ok_29
    s_sleep 2
    s_branch L_spin_30
L_slow_31:
    s_mov_b32 s3, 16384
L_spin_33:
    s_mov_b64 exec, 15
    buffer_load_dword v30, v28, s[40:43], 0 offen sc1
    s_mov_b64 exec, -1
    s_sub_u32 s3, s3, 1
    s_cbranch_scc1 L_ok_32
    s_waitcnt vmcnt(0)
    v_cmp_ne_u32 vcc, s49, v30
    s_nop 1
    s_and_b32 s53, vcc_lo, 4
    s_cbranch_scc0 L_ok_32
    s_sleep 2
    s_branch L_spin_33
.p2align 6
L_S:
    s_sub_u32 s48, s48, 4
    s_cmp_lg_u32 s48, 3
    s_cbranch_scc1 L_nocp_35
    s_getpc_b64 s[52:53]
L_pc:
    s_sub_u32 s52, s52, L_pc-gated_mix__ssm_conv_s5__dense_activation_squared_relu__prompt_kernel
    s_subb_u32 s53, s53, 0
    v_and_b32 v31, 7, v1
    v_lshl_add_u32 v31, v31, 5, s51
    v_min_u32 v31, (L_end-gated_mix__ssm_conv_s5__dense_activation_squared_relu__prompt_kernel)/128, v31
    v_lshlrev_b32 v31, 7, v31
    s_mov_b64 exec, 0xff
    global_load_dword v32, v31, s[52:53]
    s_mov_b64 exec, -1
L_nocp_35:
    v_lshrrev_b32 v38, 3, v1
    v_mul_u32_u24 v38, 1280, v38
    v_and_b32 v39, 7, v1
    v_lshl_add_u32 v7, v39, 4, v38
    s_lshr_b32 s50, s48, 1
    s_and_b32 s51, s48, 1
    v_lshrrev_b32 v39, 4, v1
    v_lshl_add_u32 v39, v39, 1, s50
    v_lshlrev_b32 v39, 4, v39
    v_xor_b32 v4, v39, v7
    v_add_u32 v5, 9216, v4
    v_add_u32 v6, 20480, v4
    s_mul_i32 s66, s45, 51200
    s_mul_i32 s52, s51, 30720
    s_add_u32 s66, s66, s52
    s_mul_i32 s68, s50, 5120
    s_mul_i32 s52, s51, 3072
    s_add_u32 s68, s68, s52
    s_add_u32 s68, s68, 47104
    s_add_u32 s69, s68, 2048
    s_cmp_eq_u32 s51, 0
    s_cselect_b64 vcc, -1, 0
    s_cselect_b32 s67, s66, 0
    s_cselect_b32 s69, s69, 57344
    s_cselect_b64 s[64:65], -1, 0xff
    v_cndmask_b32 v6, v2, v6, vcc
    s_lshl4_add_u32 s74, s44, s45
    s_lshl1_add_u32 s74, s74, s48
    s_mul_i32 s74, s74, 5120
    s_and_b32 s75, s44, 7
    s_mul_i32 s75, s75, 5
    s_mul_i32 s76, s45, 40
    s_add_u32 s75, s75, s76
    s_mul_i32 s75, s75, 1280
    s_lshl2_add_u32 s76, s44, s47
    s_mul_i32 s76, s76, 27648
    s_mul_i32 s77, s46, 768
    s_add_u32 s76, s76, s77
    s_add_u32 s76, s76, 196480
    s_mov_b32 s77, 35
    s_cmp_eq_u32 s48, 2
    s_cselect_b32 s77, 44, s77
    s_cselect_b32 s74, s75, s74
    s_movk_i32 s75, 128
    s_cmp_eq_u32 s48, 3
    s_cselect_b32 s77, 53, s77
    s_cselect_b32 s74, s76, s74
    s_cselect_b32 s75, 2304, s75
    s_movk_i32 s76, 456
    s_cselect_b32 s76, 683, s76
    s_add_u32 s74, s74, 128
    v_min_u32 v30, s77, v1
    v_mul_u32_u24 v33, s76, v30
    v_lshrrev_b32 v33, 12, v33
    v_mul_u32_u24 v33, s75, v33
    v_lshl_add_u32 v30, v30, 7, v33
    v_add_u32 v7, s74, v30
    s_mul_i32 s78, s45, 80
    v_and_b32 v38, 62, v1
    v_add_u32 v38, s78, v38
    v_and_b32 v39, 14, v1
    v_add_u32 v39, s78, v39
    s_setprio 3
    s_waitcnt lgkmcnt(0)
    global_load_ushort v157, v38, s[18:19]
    global_load_ushort v158, v39, s[18:19] offset:64
    global_load_ushort v153, v38, s[6:7]
    global_load_ushort v154, v39, s[6:7] offset:64
    global_load_ushort v155, v38, s[8:9]
    global_load_ushort v156, v39, s[8:9] offset:64
    s_setprio 0
    s_cmp_lt_u32 s44, 8
    s_cselect_b64 s[70:71], s[10:11], s[12:13]
    s_cmp_eq_u32 s48, 3
    s_cselect_b64 s[70:71], s[24:25], s[70:71]
    s_cmp_lt_u32 s48, 2
    s_cselect_b64 s[70:71], s[4:5], s[70:71]
    s_cmp_eq_u32 s50, 0
    s_cselect_b32 s56, s10, s12
    s_cselect_b32 s57, s11, s13
    s_mov_b32 s58, 0xc8000
    s_mov_b32 s59, 0x20000
    s_cmp_eq_u32 s51, 0
    s_cselect_b32 s60, s56, s32
    s_cselect_b32 s61, s57, s33
    s_cselect_b32 s62, s58, 1280
    s_mov_b32 s63, 0x20000
    s_mov_b32 s40, s38
    s_mov_b32 s41, s39
    s_mov_b32 s42, 0x10000000
    s_mov_b32 s43, 0x20000
    buffer_load_dword v3, off, s[40:43], 0 sc1
    s_add_u32 m0, s68, 0
    s_nop 0
    buffer_load_dwordx4 v4, s[56:59], s66 offen lds
    buffer_load_dwordx4 v5, s[56:59], s66 offen offset:1024 lds
    s_add_u32 m0, s69, 0
    s_add_u32 s66, s66, 128
    s_mov_b64 exec, s[64:65]
    buffer_load_dwordx4 v6, s[60:63], s67 offen lds
    s_mov_b64 exec, -1
    s_add_u32 s67, s67, 128
    s_add_u32 m0, s68, 39040
    s_nop 0
    buffer_load_dwordx4 v4, s[56:59], s66 offen lds
    buffer_load_dwordx4 v5, s[56:59], s66 offen offset:1024 lds
    s_add_u32 m0, s69, 39040
    s_add_u32 s66, s66, 128
    s_mov_b64 exec, s[64:65]
    buffer_load_dwordx4 v6, s[60:63], s67 offen lds
    s_mov_b64 exec, -1
    s_add_u32 s67, s67, 128
    global_load_dword v22, v7, s[70:71]
    v_bfe_u32 v38, v1, 2, 2
    v_and_b32 v39, 3, v1
    v_lshl_add_u32 v39, v38, 3, v39
    v_lshlrev_b32 v40, 2, v38
    v_and_b32 v40, 4, v40
    v_and_or_b32 v40, v38, 2, v40
    v_bfe_u32 v38, v1, 1, 1
    v_lshrrev_b32 v41, 4, v1
    v_xor_b32 v40, v40, v38
    v_xor_b32 v40, v40, v41
    v_lshlrev_b32 v40, 4, v40
    v_lshl_add_u32 v40, v39, 7, v40
    s_lshl_b32 s50, s48, 12
    s_add_u32 s50, s50, 30720
    v_xor_b32 v9, 544, v40
    v_xor_b32 v10, 64, v40
    v_xor_b32 v11, 608, v40
    v_add_u32 v8, s50, v40
    v_add_u32 v9, s50, v9
    v_add_u32 v10, s50, v10
    v_add_u32 v11, s50, v11
    v_add_u32 v12, 78080, v8
    v_add_u32 v13, 78080, v9
    v_add_u32 v14, 78080, v10
    v_add_u32 v15, 78080, v11
    v_and_b32 v38, 1, v1
    v_bfe_u32 v39, v1, 1, 3
    v_and_or_b32 v40, v39, 6, v38
    v_mad_u32_u24 v39, v38, 40, v39
    v_xor_b32 v40, v40, v41
    v_lshlrev_b32 v40, 4, v40
    v_lshl_add_u32 v39, v39, 7, v40
    v_add_u32 v16, 47104, v39
    v_xor_b32 v17, 64, v16
    v_add_u32 v18, 78080, v16
    v_add_u32 v19, 78080, v17
    v_lshl_add_u32 v20, s48, 2, v41
    v_cvt_f32_u32 v38, v38
    v_fma_f32 v21, v38, 2.0, -1.0
    v_mov_b32 v39, 156800
    v_lshl_add_u32 v39, v1, 2, v39
    v_mov_b32 v40, 0
    s_mov_b64 exec, 0xffff
    ds_write_b32 v39, v40
    s_mov_b64 exec, -1
    s_mov_b32 s4, 0xffff0000
    s_mov_b32 s5, 0x0
    s_cmp_eq_u32 s48, 1
    s_cselect_b64 s[36:37], -1, 0
    s_mov_b32 s6, 0x0
    s_mov_b32 s7, 0xffff
    s_cmp_eq_u32 s48, 2
    s_cselect_b64 s[22:23], -1, 0
    s_mov_b32 s8, 0x0
    s_mov_b32 s9, 0xffff0000
    s_cmp_eq_u32 s48, 3
    s_cselect_b64 s[26:27], -1, 0
    s_mov_b32 s10, 0
    s_mov_b32 s11, -1
    s_mov_b32 s12, 0xffff0000
    s_mov_b32 s13, 0xffff0000
    v_and_b32 v40, 15, v1
    v_lshlrev_b32 v39, 4, v40
    v_add_u32 v24, 154240, v39
    v_lshl_add_u32 v25, s48, 2, v24
    v_mov_b32 v26, 156800
    v_lshl_add_u32 v27, s48, 2, v26
    v_mov_b32 v28, -1
    s_cmp_eq_u32 s48, 0
    s_cselect_b32 s74, 0, 0x80000000
    v_lshl_add_u32 v29, v1, 3, s74
    s_lshl4_add_u32 s75, s44, s45
    s_lshl_b32 s75, s75, 12
    s_add_u32 s75, s75, 0x100000
    s_sub_u32 s50, s44, 1
    v_sub_u32 v38, s50, v20
    s_lshl_b32 s51, s45, 12
    s_add_u32 s51, s51, 0x100000
    v_cmp_gt_i32 s[18:19], 0, v38
    v_lshl_add_u32 v39, v40, 3, s51
    v_lshlrev_b32 v38, 16, v38
    v_add_u32 v38, v38, v39
    v_mov_b32 v41, 0x80000000
    v_cndmask_b32 v30, v38, v41, s[18:19]
    v_lshlrev_b32 v31, 5, v20
    v_add_u32 v31, 156928, v31
    s_mul_i32 s50, s48, 39040
    s_add_u32 s50, s50, 61440
    s_cmp_eq_u32 s48, 3
    s_cselect_b32 s50, 147840, s50
    v_mul_u32_u24 v38, 80, v40
    v_and_b32 v39, 48, v1
    v_add3_u32 v34, v38, v39, s50
    v_and_b32 v39, 32, v1
    v_bfe_u32 v38, v1, 2, 2
    v_bfe_u32 v40, v1, 4, 1
    v_lshl_add_u32 v38, v38, 1, v40
    v_mul_u32_u24 v38, 80, v38
    v_and_b32 v41, 3, v1
    v_lshl_add_u32 v38, v41, 3, v38
    v_add3_u32 v35, v38, v39, s50
    v_lshrrev_b32 v38, 5, v1
    v_mul_u32_u24 v38, 89600, v38
    v_add_u32 v36, v38, v2
    s_lshl2_add_u32 s78, s44, s48
    s_mul_i32 s78, s78, 180224
    s_mul_i32 s51, s45, 2560
    s_add_u32 s78, s78, s51
    s_add_u32 s78, s78, 0x80c000
    s_lshl_b32 s79, s48, 7
    s_add_u32 s79, s79, s75
    s_add_u32 s79, s79, 1280
    s_nop 0
    s_waitcnt vmcnt(8)
    v_lshlrev_b32 v157, 16, v157
    v_lshlrev_b32 v158, 16, v158
    v_lshlrev_b32 v153, 16, v153
    v_lshlrev_b32 v154, 16, v154
    v_lshlrev_b32 v155, 16, v155
    v_lshlrev_b32 v156, 16, v156
    v_mul_f32 v157, 0x3fb8aa3b, v157
    v_mul_f32 v158, 0x3fb8aa3b, v158
    v_exp_f32 v157, v157
    v_exp_f32 v158, v158
    v_cvt_pk_bf16_f32 v157, v157, v157
    v_cvt_pk_bf16_f32 v158, v158, v158
    v_lshlrev_b32 v157, 16, v157
    v_lshlrev_b32 v158, 16, v158
    v_mul_f32 v212, v157, v153
    v_mul_f32 v216, v158, v154
    v_mul_f32 v217, v157, v155
    v_mul_f32 v221, v158, v156
    v_mul_f32 v212, 0x3fb8aa3b, v212
    v_mul_f32 v216, 0x3fb8aa3b, v216
    v_mul_f32 v217, 0.15915494, v217
    v_mul_f32 v221, 0.15915494, v221
    v_exp_f32 v138, v212
    v_exp_f32 v142, v216
    v_fract_f32 v143, v217
    v_fract_f32 v147, v221
    v_cos_f32 v148, v143
    v_cos_f32 v152, v147
    v_sin_f32 v143, v143
    v_sin_f32 v147, v147
    v_mul_f32 v162, v138, v148
    v_mul_f32 v166, v142, v152
    v_mul_f32 v159, v138, v143
    v_mul_f32 v160, v142, v147
    v_mul_f32 v167, v21, v159
    v_mul_f32 v171, v21, v160
    v_add_f32 v148, -1.0, v162
    v_add_f32 v152, -1.0, v166
    v_mul_f32 v138, v153, v153
    v_mul_f32 v142, v154, v154
    v_fmac_f32 v138, v155, v155
    v_fmac_f32 v142, v156, v156
    v_rcp_f32 v138, v138
    v_rcp_f32 v142, v142
    v_mul_f32 v172, v148, v153
    v_mul_f32 v176, v152, v154
    v_fmac_f32 v172, v159, v155
    v_fmac_f32 v176, v160, v156
    v_mul_f32 v177, v159, v153
    v_mul_f32 v181, v160, v154
    v_fma_f32 v177, -v148, v155, v177
    v_fma_f32 v181, -v152, v156, v181
    v_mul_f32 v138, -2.0, v138
    v_mul_f32 v142, -2.0, v142
    v_mul_f32 v172, v138, v172
    v_mul_f32 v176, v142, v176
    v_mul_f32 v177, v138, v177
    v_mul_f32 v181, v142, v181
    v_mul_f32 v172, v21, v172
    v_mul_f32 v176, v21, v176
    v_mul_f32 v138, 0x41000000, v212
    v_mul_f32 v142, 0x41000000, v216
    v_mul_f32 v143, 0x41000000, v217
    v_mul_f32 v147, 0x41000000, v221
    v_exp_f32 v138, v138
    v_exp_f32 v142, v142
    v_fract_f32 v143, v143
    v_fract_f32 v147, v147
    v_cos_f32 v148, v143
    v_cos_f32 v152, v147
    v_sin_f32 v143, v143
    v_sin_f32 v147, v147
    v_mul_f32 v182, v138, v148
    v_mul_f32 v186, v142, v152
    v_mul_f32 v138, v21, v138
    v_mul_f32 v142, v21, v142
    v_mul_f32 v187, v138, v143
    v_mul_f32 v191, v142, v147
    v_mul_f32 v138, v187, v187
    v_mul_f32 v142, v191, v191
    v_add_f32 v148, v182, v182
    v_add_f32 v152, v186, v186
    v_fma_f32 v192, v182, v182, -v138
    v_fma_f32 v196, v186, v186, -v142
    v_mul_f32 v197, v148, v187
    v_mul_f32 v201, v152, v191
    v_mul_f32 v138, v197, v197
    v_mul_f32 v142, v201, v201
    v_add_f32 v148, v192, v192
    v_add_f32 v152, v196, v196
    v_fma_f32 v202, v192, v192, -v138
    v_fma_f32 v206, v196, v196, -v142
    v_mul_f32 v207, v148, v197
    v_mul_f32 v211, v152, v201
    v_mov_b32 v163, v162
    v_mov_b32 v168, v167
    v_mov_b32 v173, v172
    v_mov_b32 v178, v177
    v_mov_b32 v183, v182
    v_mov_b32 v188, v187
    v_mov_b32 v193, v192
    v_mov_b32 v198, v197
    v_mov_b32 v203, v202
    v_mov_b32 v208, v207
    v_mov_b32 v213, v212
    v_mov_b32 v218, v217
    v_permlane16_swap_b32 v162, v163
    v_permlane16_swap_b32 v167, v168
    v_permlane16_swap_b32 v172, v173
    v_permlane16_swap_b32 v177, v178
    v_permlane16_swap_b32 v182, v183
    v_permlane16_swap_b32 v187, v188
    v_permlane16_swap_b32 v192, v193
    v_permlane16_swap_b32 v197, v198
    v_permlane16_swap_b32 v202, v203
    v_permlane16_swap_b32 v207, v208
    v_permlane16_swap_b32 v212, v213
    v_permlane16_swap_b32 v217, v218
    v_mov_b32 v164, v162
    v_mov_b32 v165, v163
    v_mov_b32 v169, v167
    v_mov_b32 v170, v168
    v_mov_b32 v174, v172
    v_mov_b32 v175, v173
    v_mov_b32 v179, v177
    v_mov_b32 v180, v178
    v_mov_b32 v184, v182
    v_mov_b32 v185, v183
    v_mov_b32 v189, v187
    v_mov_b32 v190, v188
    v_mov_b32 v194, v192
    v_mov_b32 v195, v193
    v_mov_b32 v199, v197
    v_mov_b32 v200, v198
    v_mov_b32 v204, v202
    v_mov_b32 v205, v203
    v_mov_b32 v209, v207
    v_mov_b32 v210, v208
    v_mov_b32 v214, v212
    v_mov_b32 v215, v213
    v_mov_b32 v219, v217
    v_mov_b32 v220, v218
    v_permlane32_swap_b32 v162, v164
    v_permlane32_swap_b32 v163, v165
    v_permlane32_swap_b32 v167, v169
    v_permlane32_swap_b32 v168, v170
    v_permlane32_swap_b32 v172, v174
    v_permlane32_swap_b32 v173, v175
    v_permlane32_swap_b32 v177, v179
    v_permlane32_swap_b32 v178, v180
    v_permlane32_swap_b32 v182, v184
    v_permlane32_swap_b32 v183, v185
    v_permlane32_swap_b32 v187, v189
    v_permlane32_swap_b32 v188, v190
    v_permlane32_swap_b32 v192, v194
    v_permlane32_swap_b32 v193, v195
    v_permlane32_swap_b32 v197, v199
    v_permlane32_swap_b32 v198, v200
    v_permlane32_swap_b32 v202, v204
    v_permlane32_swap_b32 v203, v205
    v_permlane32_swap_b32 v207, v209
    v_permlane32_swap_b32 v208, v210
    v_permlane32_swap_b32 v212, v214
    v_permlane32_swap_b32 v213, v215
    v_permlane32_swap_b32 v217, v219
    v_permlane32_swap_b32 v218, v220
    v_lshlrev_b32 v23, 7, v1
    s_lshl2_add_u32 s50, s44, s47
    s_mul_i32 s50, s50, 163840
    s_add_u32 s50, s50, 0x1400000
    s_cmp_eq_u32 s48, 1
    s_cselect_b32 s50, s50, s78
    s_cmp_eq_u32 s48, 0
    s_cselect_b32 s50, s75, s50
    s_cselect_b64 exec, 0x3fffff, 1
    buffer_load_dword v22, v23, s[40:43], s50 offen sc1
    s_mul_i32 s50, s44, 327680
    s_cmp_eq_u32 s48, 1
    s_cselect_b64 s[52:53], s[20:21], s[30:31]
    s_cmp_eq_u32 s48, 0
    s_cselect_b64 s[52:53], s[34:35], s[52:53]
    s_cselect_b32 s50, s50, 0
    s_mov_b64 exec, 0x3ff
    v_add_u32 v33, s50, v23
    global_load_dword v22, v33, s[52:53]
    s_mov_b64 exec, -1
    s_waitcnt vmcnt(6) lgkmcnt(0)
    s_barrier
    ds_read_b128 v[82:85], v8 offset:0
    ds_read_b128 v[86:89], v9 offset:0
    ds_read_b128 v[90:93], v16 offset:0
    ds_read_b128 v[94:97], v16 offset:1024
    ds_read_b128 v[98:101], v16 offset:2048
    ds_read_b128 v[102:105], v16 offset:3072
    ds_read_b128 v[106:109], v16 offset:4096
    v_readfirstlane_b32 s49, v3
    s_nop 3
    s_mul_i32 s49, s49, 0x9e3779b1
    s_add_u32 s49, s49, 0x7f4a7c15
    v_mov_b32 v37, s49
    s_waitcnt lgkmcnt(0)
    v_mfma_f32_16x16x32_bf16 v[42:45], v[82:85], v[90:93], 0
    ds_read_b128 v[110:113], v10 offset:0
    ds_read_b128 v[114:117], v11 offset:0
    v_mfma_f32_16x16x32_bf16 v[46:49], v[86:89], v[90:93], 0
    ds_read_b128 v[118:121], v17 offset:0
    v_mfma_f32_16x16x32_bf16 v[50:53], v[82:85], v[94:97], 0
    ds_read_b128 v[122:125], v17 offset:1024
    ds_read_b128 v[126:129], v17 offset:2048
    v_mfma_f32_16x16x32_bf16 v[54:57], v[86:89], v[94:97], 0
    ds_read_b128 v[130:133], v17 offset:3072
    v_mfma_f32_16x16x32_bf16 v[58:61], v[82:85], v[98:101], 0
    ds_read_b128 v[134:137], v17 offset:4096
    s_add_u32 m0, s68, 78080
    v_mfma_f32_16x16x32_bf16 v[62:65], v[86:89], v[98:101], 0
    s_nop 0
    v_mfma_f32_16x16x32_bf16 v[66:69], v[82:85], v[102:105], 0
    buffer_load_dwordx4 v4, s[56:59], s66 offen lds
    buffer_load_dwordx4 v5, s[56:59], s66 offen offset:1024 lds
    v_mfma_f32_16x16x32_bf16 v[70:73], v[86:89], v[102:105], 0
    s_add_u32 m0, s69, 78080
    v_mfma_f32_16x16x32_bf16 v[74:77], v[82:85], v[106:109], 0
    s_add_u32 s66, s66, 128
    s_mov_b64 exec, s[64:65]
    buffer_load_dwordx4 v6, s[60:63], s67 offen lds
    s_mov_b64 exec, -1
    v_mfma_f32_16x16x32_bf16 v[78:81], v[86:89], v[106:109], 0
    s_add_u32 s67, s67, 128
    s_waitcnt vmcnt(6) lgkmcnt(0)
    s_barrier
    v_mfma_f32_16x16x32_bf16 v[42:45], v[110:113], v[118:121], v[42:45]
    ds_read_b128 v[82:85], v8 offset:39040
    ds_read_b128 v[86:89], v9 offset:39040
    v_mfma_f32_16x16x32_bf16 v[46:49], v[114:117], v[118:121], v[46:49]
    ds_read_b128 v[90:93], v16 offset:39040
    v_mfma_f32_16x16x32_bf16 v[50:53], v[110:113], v[122:125], v[50:53]
    ds_read_b128 v[94:97], v16 offset:40064
    v_mfma_f32_16x16x32_bf16 v[54:57], v[114:117], v[122:125], v[54:57]
    ds_read_b128 v[98:101], v16 offset:41088
    v_mfma_f32_16x16x32_bf16 v[58:61], v[110:113], v[126:129], v[58:61]
    ds_read_b128 v[102:105], v16 offset:42112
    v_mfma_f32_16x16x32_bf16 v[62:65], v[114:117], v[126:129], v[62:65]
    ds_read_b128 v[106:109], v16 offset:43136
    v_mfma_f32_16x16x32_bf16 v[66:69], v[110:113], v[130:133], v[66:69]
    s_add_u32 m0, s68, 0
    v_mfma_f32_16x16x32_bf16 v[70:73], v[114:117], v[130:133], v[70:73]
    s_nop 0
    v_mfma_f32_16x16x32_bf16 v[74:77], v[110:113], v[134:137], v[74:77]
    buffer_load_dwordx4 v4, s[56:59], s66 offen lds
    v_mfma_f32_16x16x32_bf16 v[78:81], v[114:117], v[134:137], v[78:81]
    buffer_load_dwordx4 v5, s[56:59], s66 offen offset:1024 lds
    s_waitcnt lgkmcnt(0)
    v_mfma_f32_16x16x32_bf16 v[42:45], v[82:85], v[90:93], v[42:45]
    ds_read_b128 v[110:113], v10 offset:39040
    ds_read_b128 v[114:117], v11 offset:39040
    v_mfma_f32_16x16x32_bf16 v[46:49], v[86:89], v[90:93], v[46:49]
    ds_read_b128 v[118:121], v17 offset:39040
    v_mfma_f32_16x16x32_bf16 v[50:53], v[82:85], v[94:97], v[50:53]
    ds_read_b128 v[122:125], v17 offset:40064
    v_mfma_f32_16x16x32_bf16 v[54:57], v[86:89], v[94:97], v[54:57]
    ds_read_b128 v[126:129], v17 offset:41088
    v_mfma_f32_16x16x32_bf16 v[58:61], v[82:85], v[98:101], v[58:61]
    ds_read_b128 v[130:133], v17 offset:42112
    v_mfma_f32_16x16x32_bf16 v[62:65], v[86:89], v[98:101], v[62:65]
    ds_read_b128 v[134:137], v17 offset:43136
    v_mfma_f32_16x16x32_bf16 v[66:69], v[82:85], v[102:105], v[66:69]
    s_add_u32 m0, s69, 0
    v_mfma_f32_16x16x32_bf16 v[70:73], v[86:89], v[102:105], v[70:73]
    s_add_u32 s66, s66, 128
    v_mfma_f32_16x16x32_bf16 v[74:77], v[82:85], v[106:109], v[74:77]
    s_mov_b64 exec, s[64:65]
    buffer_load_dwordx4 v6, s[60:63], s67 offen lds
    s_mov_b64 exec, -1
    v_mfma_f32_16x16x32_bf16 v[78:81], v[86:89], v[106:109], v[78:81]
    s_add_u32 s67, s67, 128
    s_waitcnt vmcnt(3) lgkmcnt(0)
    s_barrier
    v_mfma_f32_16x16x32_bf16 v[42:45], v[110:113], v[118:121], v[42:45]
    ds_read_b128 v[82:85], v12 offset:0
    ds_read_b128 v[86:89], v13 offset:0
    v_mfma_f32_16x16x32_bf16 v[46:49], v[114:117], v[118:121], v[46:49]
    ds_read_b128 v[90:93], v18 offset:0
    v_mfma_f32_16x16x32_bf16 v[50:53], v[110:113], v[122:125], v[50:53]
    ds_read_b128 v[94:97], v18 offset:1024
    v_mfma_f32_16x16x32_bf16 v[54:57], v[114:117], v[122:125], v[54:57]
    ds_read_b128 v[98:101], v18 offset:2048
    v_mfma_f32_16x16x32_bf16 v[58:61], v[110:113], v[126:129], v[58:61]
    ds_read_b128 v[102:105], v18 offset:3072
    v_mfma_f32_16x16x32_bf16 v[62:65], v[114:117], v[126:129], v[62:65]
    ds_read_b128 v[106:109], v18 offset:4096
    v_mfma_f32_16x16x32_bf16 v[66:69], v[110:113], v[130:133], v[66:69]
    s_add_u32 m0, s68, 39040
    v_mfma_f32_16x16x32_bf16 v[70:73], v[114:117], v[130:133], v[70:73]
    s_nop 0
    v_mfma_f32_16x16x32_bf16 v[74:77], v[110:113], v[134:137], v[74:77]
    buffer_load_dwordx4 v4, s[56:59], s66 offen lds
    v_mfma_f32_16x16x32_bf16 v[78:81], v[114:117], v[134:137], v[78:81]
    buffer_load_dwordx4 v5, s[56:59], s66 offen offset:1024 lds
    s_waitcnt lgkmcnt(0)
    v_mfma_f32_16x16x32_bf16 v[42:45], v[82:85], v[90:93], v[42:45]
    ds_read_b128 v[110:113], v14 offset:0
    ds_read_b128 v[114:117], v15 offset:0
    v_mfma_f32_16x16x32_bf16 v[46:49], v[86:89], v[90:93], v[46:49]
    ds_read_b128 v[118:121], v19 offset:0
    v_mfma_f32_16x16x32_bf16 v[50:53], v[82:85], v[94:97], v[50:53]
    ds_read_b128 v[122:125], v19 offset:1024
    v_mfma_f32_16x16x32_bf16 v[54:57], v[86:89], v[94:97], v[54:57]
    ds_read_b128 v[126:129], v19 offset:2048
    v_mfma_f32_16x16x32_bf16 v[58:61], v[82:85], v[98:101], v[58:61]
    ds_read_b128 v[130:133], v19 offset:3072
    v_mfma_f32_16x16x32_bf16 v[62:65], v[86:89], v[98:101], v[62:65]
    ds_read_b128 v[134:137], v19 offset:4096
    v_mfma_f32_16x16x32_bf16 v[66:69], v[82:85], v[102:105], v[66:69]
    s_add_u32 m0, s69, 39040
    v_mfma_f32_16x16x32_bf16 v[70:73], v[86:89], v[102:105], v[70:73]
    s_add_u32 s66, s66, 128
    v_mfma_f32_16x16x32_bf16 v[74:77], v[82:85], v[106:109], v[74:77]
    s_mov_b64 exec, s[64:65]
    buffer_load_dwordx4 v6, s[60:63], s67 offen lds
    s_mov_b64 exec, -1
    v_mfma_f32_16x16x32_bf16 v[78:81], v[86:89], v[106:109], v[78:81]
    s_add_u32 s67, s67, 128
    s_waitcnt vmcnt(3) lgkmcnt(0)
    s_barrier
    v_mfma_f32_16x16x32_bf16 v[42:45], v[110:113], v[118:121], v[42:45]
    ds_read_b128 v[82:85], v8 offset:0
    ds_read_b128 v[86:89], v9 offset:0
    v_mfma_f32_16x16x32_bf16 v[46:49], v[114:117], v[118:121], v[46:49]
    ds_read_b128 v[90:93], v16 offset:0
    v_mfma_f32_16x16x32_bf16 v[50:53], v[110:113], v[122:125], v[50:53]
    ds_read_b128 v[94:97], v16 offset:1024
    v_mfma_f32_16x16x32_bf16 v[54:57], v[114:117], v[122:125], v[54:57]
    ds_read_b128 v[98:101], v16 offset:2048
    v_mfma_f32_16x16x32_bf16 v[58:61], v[110:113], v[126:129], v[58:61]
    ds_read_b128 v[102:105], v16 offset:3072
    v_mfma_f32_16x16x32_bf16 v[62:65], v[114:117], v[126:129], v[62:65]
    ds_read_b128 v[106:109], v16 offset:4096
    v_mfma_f32_16x16x32_bf16 v[66:69], v[110:113], v[130:133], v[66:69]
    s_add_u32 m0, s68, 78080
    v_mfma_f32_16x16x32_bf16 v[70:73], v[114:117], v[130:133], v[70:73]
    s_nop 0
    v_mfma_f32_16x16x32_bf16 v[74:77], v[110:113], v[134:137], v[74:77]
    buffer_load_dwordx4 v4, s[56:59], s66 offen lds
    v_mfma_f32_16x16x32_bf16 v[78:81], v[114:117], v[134:137], v[78:81]
    buffer_load_dwordx4 v5, s[56:59], s66 offen offset:1024 lds
    s_waitcnt lgkmcnt(0)
    v_mfma_f32_16x16x32_bf16 v[42:45], v[82:85], v[90:93], v[42:45]
    ds_read_b128 v[110:113], v10 offset:0
    ds_read_b128 v[114:117], v11 offset:0
    v_mfma_f32_16x16x32_bf16 v[46:49], v[86:89], v[90:93], v[46:49]
    ds_read_b128 v[118:121], v17 offset:0
    ds_read_b128 v[122:125], v17 offset:1024
    v_mfma_f32_16x16x32_bf16 v[50:53], v[82:85], v[94:97], v[50:53]
    ds_read_b128 v[126:129], v17 offset:2048
    ds_read_b128 v[130:133], v17 offset:3072
    v_mfma_f32_16x16x32_bf16 v[54:57], v[86:89], v[94:97], v[54:57]
    ds_read_b128 v[134:137], v17 offset:4096
    s_add_u32 m0, s69, 78080
    v_mfma_f32_16x16x32_bf16 v[58:61], v[82:85], v[98:101], v[58:61]
    s_add_u32 s66, s66, 128
    s_mov_b64 exec, s[64:65]
    buffer_load_dwordx4 v6, s[60:63], s67 offen lds
    s_mov_b64 exec, -1
    v_mfma_f32_16x16x32_bf16 v[62:65], v[86:89], v[98:101], v[62:65]
    s_add_u32 s67, s67, 128
    s_lshl2_add_u32 s73, s44, s47
    v_mfma_f32_16x16x32_bf16 v[66:69], v[82:85], v[102:105], v[66:69]
    s_mov_b64 s[70:71], s[28:29]
    s_lshl_b32 s72, s46, 6
    v_mfma_f32_16x16x32_bf16 v[70:73], v[86:89], v[102:105], v[70:73]
    s_add_u32 s73, s73, s72
    s_lshl2_add_u32 s73, s73, s48
    v_mfma_f32_16x16x32_bf16 v[74:77], v[82:85], v[106:109], v[74:77]
    s_mul_i32 s73, s73, 15
    v_min_u32 v7, 14, v1
    v_mfma_f32_16x16x32_bf16 v[78:81], v[86:89], v[106:109], v[78:81]
    v_add_lshl_u32 v7, v7, s73, 7
    s_mov_b64 exec, 0xffff
    global_load_dword v22, v7, s[70:71]
    s_mov_b64 exec, -1
    s_waitcnt vmcnt(4) lgkmcnt(0)
    s_barrier
    v_mfma_f32_16x16x32_bf16 v[42:45], v[110:113], v[118:121], v[42:45]
    ds_read_b128 v[82:85], v8 offset:39040
    ds_read_b128 v[86:89], v9 offset:39040
    v_mfma_f32_16x16x32_bf16 v[46:49], v[114:117], v[118:121], v[46:49]
    ds_read_b128 v[90:93], v16 offset:39040
    v_mfma_f32_16x16x32_bf16 v[50:53], v[110:113], v[122:125], v[50:53]
    ds_read_b128 v[94:97], v16 offset:40064
    v_mfma_f32_16x16x32_bf16 v[54:57], v[114:117], v[122:125], v[54:57]
    ds_read_b128 v[98:101], v16 offset:41088
    v_mfma_f32_16x16x32_bf16 v[58:61], v[110:113], v[126:129], v[58:61]
    ds_read_b128 v[102:105], v16 offset:42112
    v_mfma_f32_16x16x32_bf16 v[62:65], v[114:117], v[126:129], v[62:65]
    ds_read_b128 v[106:109], v16 offset:43136
    v_mfma_f32_16x16x32_bf16 v[66:69], v[110:113], v[130:133], v[66:69]
    s_add_u32 m0, s68, 0
    v_mfma_f32_16x16x32_bf16 v[70:73], v[114:117], v[130:133], v[70:73]
    s_nop 0
    v_mfma_f32_16x16x32_bf16 v[74:77], v[110:113], v[134:137], v[74:77]
    buffer_load_dwordx4 v4, s[56:59], s66 offen lds
    v_mfma_f32_16x16x32_bf16 v[78:81], v[114:117], v[134:137], v[78:81]
    buffer_load_dwordx4 v5, s[56:59], s66 offen offset:1024 lds
    s_waitcnt lgkmcnt(0)
    v_mfma_f32_16x16x32_bf16 v[42:45], v[82:85], v[90:93], v[42:45]
    ds_read_b128 v[110:113], v10 offset:39040
    ds_read_b128 v[114:117], v11 offset:39040
    v_mfma_f32_16x16x32_bf16 v[46:49], v[86:89], v[90:93], v[46:49]
    ds_read_b128 v[118:121], v17 offset:39040
    v_mfma_f32_16x16x32_bf16 v[50:53], v[82:85], v[94:97], v[50:53]
    ds_read_b128 v[122:125], v17 offset:40064
    v_mfma_f32_16x16x32_bf16 v[54:57], v[86:89], v[94:97], v[54:57]
    ds_read_b128 v[126:129], v17 offset:41088
    v_mfma_f32_16x16x32_bf16 v[58:61], v[82:85], v[98:101], v[58:61]
    ds_read_b128 v[130:133], v17 offset:42112
    v_mfma_f32_16x16x32_bf16 v[62:65], v[86:89], v[98:101], v[62:65]
    ds_read_b128 v[134:137], v17 offset:43136
    v_mfma_f32_16x16x32_bf16 v[66:69], v[82:85], v[102:105], v[66:69]
    s_add_u32 m0, s69, 0
    v_mfma_f32_16x16x32_bf16 v[70:73], v[86:89], v[102:105], v[70:73]
    s_add_u32 s66, s66, 128
    v_mfma_f32_16x16x32_bf16 v[74:77], v[82:85], v[106:109], v[74:77]
    s_mov_b64 exec, s[64:65]
    buffer_load_dwordx4 v6, s[60:63], s67 offen lds
    s_mov_b64 exec, -1
    v_mfma_f32_16x16x32_bf16 v[78:81], v[86:89], v[106:109], v[78:81]
    s_add_u32 s67, s67, 128
    s_waitcnt vmcnt(4) lgkmcnt(0)
    s_barrier
    v_mfma_f32_16x16x32_bf16 v[42:45], v[110:113], v[118:121], v[42:45]
    ds_read_b128 v[82:85], v12 offset:0
    ds_read_b128 v[86:89], v13 offset:0
    v_mfma_f32_16x16x32_bf16 v[46:49], v[114:117], v[118:121], v[46:49]
    ds_read_b128 v[90:93], v18 offset:0
    v_mfma_f32_16x16x32_bf16 v[50:53], v[110:113], v[122:125], v[50:53]
    ds_read_b128 v[94:97], v18 offset:1024
    v_mfma_f32_16x16x32_bf16 v[54:57], v[114:117], v[122:125], v[54:57]
    ds_read_b128 v[98:101], v18 offset:2048
    v_mfma_f32_16x16x32_bf16 v[58:61], v[110:113], v[126:129], v[58:61]
    ds_read_b128 v[102:105], v18 offset:3072
    v_mfma_f32_16x16x32_bf16 v[62:65], v[114:117], v[126:129], v[62:65]
    ds_read_b128 v[106:109], v18 offset:4096
    v_mfma_f32_16x16x32_bf16 v[66:69], v[110:113], v[130:133], v[66:69]
    s_add_u32 m0, s68, 39040
    v_mfma_f32_16x16x32_bf16 v[70:73], v[114:117], v[130:133], v[70:73]
    s_nop 0
    v_mfma_f32_16x16x32_bf16 v[74:77], v[110:113], v[134:137], v[74:77]
    buffer_load_dwordx4 v4, s[56:59], s66 offen lds
    v_mfma_f32_16x16x32_bf16 v[78:81], v[114:117], v[134:137], v[78:81]
    buffer_load_dwordx4 v5, s[56:59], s66 offen offset:1024 lds
    s_waitcnt lgkmcnt(0)
    v_mfma_f32_16x16x32_bf16 v[42:45], v[82:85], v[90:93], v[42:45]
    ds_read_b128 v[110:113], v14 offset:0
    ds_read_b128 v[114:117], v15 offset:0
    v_mfma_f32_16x16x32_bf16 v[46:49], v[86:89], v[90:93], v[46:49]
    ds_read_b128 v[118:121], v19 offset:0
    v_mfma_f32_16x16x32_bf16 v[50:53], v[82:85], v[94:97], v[50:53]
    ds_read_b128 v[122:125], v19 offset:1024
    v_mfma_f32_16x16x32_bf16 v[54:57], v[86:89], v[94:97], v[54:57]
    ds_read_b128 v[126:129], v19 offset:2048
    v_mfma_f32_16x16x32_bf16 v[58:61], v[82:85], v[98:101], v[58:61]
    ds_read_b128 v[130:133], v19 offset:3072
    v_mfma_f32_16x16x32_bf16 v[62:65], v[86:89], v[98:101], v[62:65]
    ds_read_b128 v[134:137], v19 offset:4096
    v_mfma_f32_16x16x32_bf16 v[66:69], v[82:85], v[102:105], v[66:69]
    s_add_u32 m0, s69, 39040
    v_mfma_f32_16x16x32_bf16 v[70:73], v[86:89], v[102:105], v[70:73]
    s_add_u32 s66, s66, 128
    v_mfma_f32_16x16x32_bf16 v[74:77], v[82:85], v[106:109], v[74:77]
    s_mov_b64 exec, s[64:65]
    buffer_load_dwordx4 v6, s[60:63], s67 offen lds
    s_mov_b64 exec, -1
    v_mfma_f32_16x16x32_bf16 v[78:81], v[86:89], v[106:109], v[78:81]
    s_add_u32 s67, s67, 128
    s_waitcnt vmcnt(3) lgkmcnt(0)
    s_barrier
    v_mfma_f32_16x16x32_bf16 v[42:45], v[110:113], v[118:121], v[42:45]
    ds_read_b128 v[82:85], v8 offset:0
    ds_read_b128 v[86:89], v9 offset:0
    v_mfma_f32_16x16x32_bf16 v[46:49], v[114:117], v[118:121], v[46:49]
    ds_read_b128 v[90:93], v16 offset:0
    v_mfma_f32_16x16x32_bf16 v[50:53], v[110:113], v[122:125], v[50:53]
    ds_read_b128 v[94:97], v16 offset:1024
    v_mfma_f32_16x16x32_bf16 v[54:57], v[114:117], v[122:125], v[54:57]
    ds_read_b128 v[98:101], v16 offset:2048
    v_mfma_f32_16x16x32_bf16 v[58:61], v[110:113], v[126:129], v[58:61]
    ds_read_b128 v[102:105], v16 offset:3072
    v_mfma_f32_16x16x32_bf16 v[62:65], v[114:117], v[126:129], v[62:65]
    ds_read_b128 v[106:109], v16 offset:4096
    v_mfma_f32_16x16x32_bf16 v[66:69], v[110:113], v[130:133], v[66:69]
    s_add_u32 m0, s68, 78080
    v_mfma_f32_16x16x32_bf16 v[70:73], v[114:117], v[130:133], v[70:73]
    s_nop 0
    v_mfma_f32_16x16x32_bf16 v[74:77], v[110:113], v[134:137], v[74:77]
    buffer_load_dwordx4 v4, s[56:59], s66 offen lds
    v_mfma_f32_16x16x32_bf16 v[78:81], v[114:117], v[134:137], v[78:81]
    buffer_load_dwordx4 v5, s[56:59], s66 offen offset:1024 lds
    s_waitcnt lgkmcnt(0)
    v_mfma_f32_16x16x32_bf16 v[42:45], v[82:85], v[90:93], v[42:45]
    ds_read_b128 v[110:113], v10 offset:0
    ds_read_b128 v[114:117], v11 offset:0
    ds_read_b128 v[118:121], v17 offset:0
    v_mfma_f32_16x16x32_bf16 v[46:49], v[86:89], v[90:93], v[46:49]
    ds_read_b128 v[122:125], v17 offset:1024
    ds_read_b128 v[126:129], v17 offset:2048
    v_mfma_f32_16x16x32_bf16 v[50:53], v[82:85], v[94:97], v[50:53]
    ds_read_b128 v[130:133], v17 offset:3072
    ds_read_b128 v[134:137], v17 offset:4096
    s_add_u32 m0, s69, 78080
    v_mfma_f32_16x16x32_bf16 v[54:57], v[86:89], v[94:97], v[54:57]
    s_add_u32 s66, s66, 128
    s_mov_b64 exec, s[64:65]
    buffer_load_dwordx4 v6, s[60:63], s67 offen lds
    s_mov_b64 exec, -1
    v_mfma_f32_16x16x32_bf16 v[58:61], v[82:85], v[98:101], v[58:61]
    s_add_u32 s67, s67, 128
    s_lshl2_add_u32 s73, s44, s47
    s_cmp_lt_u32 s48, 2
    s_cselect_b64 s[70:71], s[14:15], s[16:17]
    v_mfma_f32_16x16x32_bf16 v[62:65], v[86:89], v[98:101], v[62:65]
    s_and_b32 s72, s48, 1
    s_lshl1_add_u32 s73, s73, s72
    v_mfma_f32_16x16x32_bf16 v[66:69], v[82:85], v[102:105], v[66:69]
    s_mul_i32 s73, s73, 50
    s_mul_i32 s72, s46, 5
    s_lshr_b32 s72, s72, 1
    v_mfma_f32_16x16x32_bf16 v[70:73], v[86:89], v[102:105], v[70:73]
    s_add_u32 s73, s73, s72
    v_min_u32 v7, 14, v1
    v_mfma_f32_16x16x32_bf16 v[74:77], v[82:85], v[106:109], v[74:77]
    v_mul_u32_u24 v23, 43, v7
    v_lshrrev_b32 v23, 7, v23
    v_mad_u32_u24 v7, v23, 7, v7
    v_mfma_f32_16x16x32_bf16 v[78:81], v[86:89], v[106:109], v[78:81]
    v_add_lshl_u32 v7, v7, s73, 7
    s_mov_b64 exec, 0xffff
    global_load_dword v22, v7, s[70:71]
    s_mov_b64 exec, -1
    s_waitcnt vmcnt(4) lgkmcnt(0)
    s_barrier
    v_mfma_f32_16x16x32_bf16 v[42:45], v[110:113], v[118:121], v[42:45]
    ds_read_b128 v[82:85], v8 offset:39040
    ds_read_b128 v[86:89], v9 offset:39040
    v_mfma_f32_16x16x32_bf16 v[46:49], v[114:117], v[118:121], v[46:49]
    ds_read_b128 v[90:93], v16 offset:39040
    v_mfma_f32_16x16x32_bf16 v[50:53], v[110:113], v[122:125], v[50:53]
    ds_read_b128 v[94:97], v16 offset:40064
    v_mfma_f32_16x16x32_bf16 v[54:57], v[114:117], v[122:125], v[54:57]
    ds_read_b128 v[98:101], v16 offset:41088
    v_mfma_f32_16x16x32_bf16 v[58:61], v[110:113], v[126:129], v[58:61]
    ds_read_b128 v[102:105], v16 offset:42112
    v_mfma_f32_16x16x32_bf16 v[62:65], v[114:117], v[126:129], v[62:65]
    ds_read_b128 v[106:109], v16 offset:43136
    v_mfma_f32_16x16x32_bf16 v[66:69], v[110:113], v[130:133], v[66:69]
    s_add_u32 m0, s68, 0
    v_mfma_f32_16x16x32_bf16 v[70:73], v[114:117], v[130:133], v[70:73]
    s_nop 0
    v_mfma_f32_16x16x32_bf16 v[74:77], v[110:113], v[134:137], v[74:77]
    buffer_load_dwordx4 v4, s[56:59], s66 offen lds
    v_mfma_f32_16x16x32_bf16 v[78:81], v[114:117], v[134:137], v[78:81]
    buffer_load_dwordx4 v5, s[56:59], s66 offen offset:1024 lds
    s_waitcnt lgkmcnt(0)
    v_mfma_f32_16x16x32_bf16 v[42:45], v[82:85], v[90:93], v[42:45]
    ds_read_b128 v[110:113], v10 offset:39040
    ds_read_b128 v[114:117], v11 offset:39040
    v_mfma_f32_16x16x32_bf16 v[46:49], v[86:89], v[90:93], v[46:49]
    ds_read_b128 v[118:121], v17 offset:39040
    v_mfma_f32_16x16x32_bf16 v[50:53], v[82:85], v[94:97], v[50:53]
    ds_read_b128 v[122:125], v17 offset:40064
    v_mfma_f32_16x16x32_bf16 v[54:57], v[86:89], v[94:97], v[54:57]
    ds_read_b128 v[126:129], v17 offset:41088
    v_mfma_f32_16x16x32_bf16 v[58:61], v[82:85], v[98:101], v[58:61]
    ds_read_b128 v[130:133], v17 offset:42112
    v_mfma_f32_16x16x32_bf16 v[62:65], v[86:89], v[98:101], v[62:65]
    ds_read_b128 v[134:137], v17 offset:43136
    v_mfma_f32_16x16x32_bf16 v[66:69], v[82:85], v[102:105], v[66:69]
    s_add_u32 m0, s69, 0
    v_mfma_f32_16x16x32_bf16 v[70:73], v[86:89], v[102:105], v[70:73]
    s_add_u32 s66, s66, 128
    v_mfma_f32_16x16x32_bf16 v[74:77], v[82:85], v[106:109], v[74:77]
    s_mov_b64 exec, s[64:65]
    buffer_load_dwordx4 v6, s[60:63], s67 offen lds
    s_mov_b64 exec, -1
    v_mfma_f32_16x16x32_bf16 v[78:81], v[86:89], v[106:109], v[78:81]
    s_add_u32 s67, s67, 128
    s_waitcnt vmcnt(4) lgkmcnt(0)
    s_barrier
    v_mfma_f32_16x16x32_bf16 v[42:45], v[110:113], v[118:121], v[42:45]
    ds_read_b128 v[82:85], v12 offset:0
    v_mfma_f32_16x16x32_bf16 v[46:49], v[114:117], v[118:121], v[46:49]
    ds_read_b128 v[86:89], v13 offset:0
    v_mfma_f32_16x16x32_bf16 v[50:53], v[110:113], v[122:125], v[50:53]
    ds_read_b128 v[90:93], v18 offset:0
    v_mfma_f32_16x16x32_bf16 v[54:57], v[114:117], v[122:125], v[54:57]
    v_mfma_f32_16x16x32_bf16 v[58:61], v[110:113], v[126:129], v[58:61]
    ds_read_b128 v[94:97], v18 offset:1024
    v_mfma_f32_16x16x32_bf16 v[62:65], v[114:117], v[126:129], v[62:65]
    ds_read_b128 v[98:101], v18 offset:2048
    v_mfma_f32_16x16x32_bf16 v[66:69], v[110:113], v[130:133], v[66:69]
    v_mfma_f32_16x16x32_bf16 v[70:73], v[114:117], v[130:133], v[70:73]
    ds_read_b128 v[102:105], v18 offset:3072
    v_mfma_f32_16x16x32_bf16 v[74:77], v[110:113], v[134:137], v[74:77]
    ds_read_b128 v[106:109], v18 offset:4096
    v_mfma_f32_16x16x32_bf16 v[78:81], v[114:117], v[134:137], v[78:81]
    s_waitcnt lgkmcnt(0)
    v_mfma_f32_16x16x32_bf16 v[42:45], v[82:85], v[90:93], v[42:45]
    ds_read_b128 v[110:113], v14 offset:0
    v_mfma_f32_16x16x32_bf16 v[46:49], v[86:89], v[90:93], v[46:49]
    ds_read_b128 v[114:117], v15 offset:0
    v_mfma_f32_16x16x32_bf16 v[50:53], v[82:85], v[94:97], v[50:53]
    ds_read_b128 v[118:121], v19 offset:0
    v_mfma_f32_16x16x32_bf16 v[54:57], v[86:89], v[94:97], v[54:57]
    v_mfma_f32_16x16x32_bf16 v[58:61], v[82:85], v[98:101], v[58:61]
    ds_read_b128 v[122:125], v19 offset:1024
    v_mfma_f32_16x16x32_bf16 v[62:65], v[86:89], v[98:101], v[62:65]
    ds_read_b128 v[126:129], v19 offset:2048
    v_mfma_f32_16x16x32_bf16 v[66:69], v[82:85], v[102:105], v[66:69]
    v_mfma_f32_16x16x32_bf16 v[70:73], v[86:89], v[102:105], v[70:73]
    ds_read_b128 v[130:133], v19 offset:3072
    v_mfma_f32_16x16x32_bf16 v[74:77], v[82:85], v[106:109], v[74:77]
    ds_read_b128 v[134:137], v19 offset:4096
    v_mfma_f32_16x16x32_bf16 v[78:81], v[86:89], v[106:109], v[78:81]
    s_waitcnt vmcnt(0) lgkmcnt(0)
    s_barrier
    v_mfma_f32_16x16x32_bf16 v[42:45], v[110:113], v[118:121], v[42:45]
    ds_read_b128 v[82:85], v8 offset:0
    v_mfma_f32_16x16x32_bf16 v[46:49], v[114:117], v[118:121], v[46:49]
    ds_read_b128 v[86:89], v9 offset:0
    v_mfma_f32_16x16x32_bf16 v[50:53], v[110:113], v[122:125], v[50:53]
    ds_read_b128 v[90:93], v16 offset:0
    v_mfma_f32_16x16x32_bf16 v[54:57], v[114:117], v[122:125], v[54:57]
    v_mfma_f32_16x16x32_bf16 v[58:61], v[110:113], v[126:129], v[58:61]
    ds_read_b128 v[94:97], v16 offset:1024
    v_mfma_f32_16x16x32_bf16 v[62:65], v[114:117], v[126:129], v[62:65]
    ds_read_b128 v[98:101], v16 offset:2048
    v_mfma_f32_16x16x32_bf16 v[66:69], v[110:113], v[130:133], v[66:69]
    v_mfma_f32_16x16x32_bf16 v[70:73], v[114:117], v[130:133], v[70:73]
    ds_read_b128 v[102:105], v16 offset:3072
    v_mfma_f32_16x16x32_bf16 v[74:77], v[110:113], v[134:137], v[74:77]
    ds_read_b128 v[106:109], v16 offset:4096
    v_mfma_f32_16x16x32_bf16 v[78:81], v[114:117], v[134:137], v[78:81]
    s_waitcnt lgkmcnt(0)
    v_mfma_f32_16x16x32_bf16 v[42:45], v[82:85], v[90:93], v[42:45]
    ds_read_b128 v[110:113], v10 offset:0
    v_mfma_f32_16x16x32_bf16 v[46:49], v[86:89], v[90:93], v[46:49]
    ds_read_b128 v[114:117], v11 offset:0
    v_mfma_f32_16x16x32_bf16 v[50:53], v[82:85], v[94:97], v[50:53]
    ds_read_b128 v[118:121], v17 offset:0
    v_mfma_f32_16x16x32_bf16 v[54:57], v[86:89], v[94:97], v[54:57]
    v_mfma_f32_16x16x32_bf16 v[58:61], v[82:85], v[98:101], v[58:61]
    ds_read_b128 v[122:125], v17 offset:1024
    v_mfma_f32_16x16x32_bf16 v[62:65], v[86:89], v[98:101], v[62:65]
    ds_read_b128 v[126:129], v17 offset:2048
    v_mfma_f32_16x16x32_bf16 v[66:69], v[82:85], v[102:105], v[66:69]
    v_mfma_f32_16x16x32_bf16 v[70:73], v[86:89], v[102:105], v[70:73]
    ds_read_b128 v[130:133], v17 offset:3072
    v_mfma_f32_16x16x32_bf16 v[74:77], v[82:85], v[106:109], v[74:77]
    ds_read_b128 v[134:137], v17 offset:4096
    v_mfma_f32_16x16x32_bf16 v[78:81], v[86:89], v[106:109], v[78:81]
    s_waitcnt lgkmcnt(0)
    s_barrier
    v_mfma_f32_16x16x32_bf16 v[42:45], v[110:113], v[118:121], v[42:45]
    v_mfma_f32_16x16x32_bf16 v[46:49], v[114:117], v[118:121], v[46:49]
    v_mfma_f32_16x16x32_bf16 v[50:53], v[110:113], v[122:125], v[50:53]
    v_mfma_f32_16x16x32_bf16 v[54:57], v[114:117], v[122:125], v[54:57]
    v_mfma_f32_16x16x32_bf16 v[58:61], v[110:113], v[126:129], v[58:61]
    v_mfma_f32_16x16x32_bf16 v[62:65], v[114:117], v[126:129], v[62:65]
    v_mfma_f32_16x16x32_bf16 v[66:69], v[110:113], v[130:133], v[66:69]
    v_mfma_f32_16x16x32_bf16 v[70:73], v[114:117], v[130:133], v[70:73]
    v_mfma_f32_16x16x32_bf16 v[74:77], v[110:113], v[134:137], v[74:77]
    v_mfma_f32_16x16x32_bf16 v[78:81], v[114:117], v[134:137], v[78:81]
    s_setprio 3
    v_mov_b32 v155, s49
    v_mov_b32 v157, s49
    s_nop 3
    v_fma_f32 v82, v162, v42, v43
    v_fma_f32 v83, v163, v50, v51
    v_fma_f32 v84, v164, v58, v59
    v_fma_f32 v85, v165, v66, v67
    v_fma_f32 v86, v166, v74, v75
    v_fmac_f32_dpp v82, v42, v167 quad_perm:[1,0,3,2] row_mask:0xf bank_mask:0xf
    v_fmac_f32_dpp v83, v50, v168 quad_perm:[1,0,3,2] row_mask:0xf bank_mask:0xf
    v_fmac_f32_dpp v84, v58, v169 quad_perm:[1,0,3,2] row_mask:0xf bank_mask:0xf
    v_fmac_f32_dpp v85, v66, v170 quad_perm:[1,0,3,2] row_mask:0xf bank_mask:0xf
    v_fmac_f32_dpp v86, v74, v171 quad_perm:[1,0,3,2] row_mask:0xf bank_mask:0xf
    v_fma_f32 v87, v162, v82, v44
    v_fma_f32 v88, v163, v83, v52
    v_fma_f32 v89, v164, v84, v60
    v_fma_f32 v90, v165, v85, v68
    v_fma_f32 v91, v166, v86, v76
    v_fmac_f32_dpp v87, v82, v167 quad_perm:[1,0,3,2] row_mask:0xf bank_mask:0xf
    v_fmac_f32_dpp v88, v83, v168 quad_perm:[1,0,3,2] row_mask:0xf bank_mask:0xf
    v_fmac_f32_dpp v89, v84, v169 quad_perm:[1,0,3,2] row_mask:0xf bank_mask:0xf
    v_fmac_f32_dpp v90, v85, v170 quad_perm:[1,0,3,2] row_mask:0xf bank_mask:0xf
    v_fmac_f32_dpp v91, v86, v171 quad_perm:[1,0,3,2] row_mask:0xf bank_mask:0xf
    v_fma_f32 v82, v162, v87, v45
    v_fma_f32 v83, v163, v88, v53
    v_fma_f32 v84, v164, v89, v61
    v_fma_f32 v85, v165, v90, v69
    v_fma_f32 v86, v166, v91, v77
    v_fmac_f32_dpp v82, v87, v167 quad_perm:[1,0,3,2] row_mask:0xf bank_mask:0xf
    v_fmac_f32_dpp v83, v88, v168 quad_perm:[1,0,3,2] row_mask:0xf bank_mask:0xf
    v_fmac_f32_dpp v84, v89, v169 quad_perm:[1,0,3,2] row_mask:0xf bank_mask:0xf
    v_fmac_f32_dpp v85, v90, v170 quad_perm:[1,0,3,2] row_mask:0xf bank_mask:0xf
    v_fmac_f32_dpp v86, v91, v171 quad_perm:[1,0,3,2] row_mask:0xf bank_mask:0xf
    v_fma_f32 v87, v162, v82, v46
    v_fma_f32 v88, v163, v83, v54
    v_fma_f32 v89, v164, v84, v62
    v_fma_f32 v90, v165, v85, v70
    v_fma_f32 v91, v166, v86, v78
    v_fmac_f32_dpp v87, v82, v167 quad_perm:[1,0,3,2] row_mask:0xf bank_mask:0xf
    v_fmac_f32_dpp v88, v83, v168 quad_perm:[1,0,3,2] row_mask:0xf bank_mask:0xf
    v_fmac_f32_dpp v89, v84, v169 quad_perm:[1,0,3,2] row_mask:0xf bank_mask:0xf
    v_fmac_f32_dpp v90, v85, v170 quad_perm:[1,0,3,2] row_mask:0xf bank_mask:0xf
    v_fmac_f32_dpp v91, v86, v171 quad_perm:[1,0,3,2] row_mask:0xf bank_mask:0xf
    v_fma_f32 v82, v162, v87, v47
    v_fma_f32 v83, v163, v88, v55
    v_fma_f32 v84, v164, v89, v63
    v_fma_f32 v85, v165, v90, v71
    v_fma_f32 v86, v166, v91, v79
    v_fmac_f32_dpp v82, v87, v167 quad_perm:[1,0,3,2] row_mask:0xf bank_mask:0xf
    v_fmac_f32_dpp v83, v88, v168 quad_perm:[1,0,3,2] row_mask:0xf bank_mask:0xf
    v_fmac_f32_dpp v84, v89, v169 quad_perm:[1,0,3,2] row_mask:0xf bank_mask:0xf
    v_fmac_f32_dpp v85, v90, v170 quad_perm:[1,0,3,2] row_mask:0xf bank_mask:0xf
    v_fmac_f32_dpp v86, v91, v171 quad_perm:[1,0,3,2] row_mask:0xf bank_mask:0xf
    v_fma_f32 v87, v162, v82, v48
    v_fma_f32 v88, v163, v83, v56
    v_fma_f32 v89, v164, v84, v64
    v_fma_f32 v90, v165, v85, v72
    v_fma_f32 v91, v166, v86, v80
    v_fmac_f32_dpp v87, v82, v167 quad_perm:[1,0,3,2] row_mask:0xf bank_mask:0xf
    v_fmac_f32_dpp v88, v83, v168 quad_perm:[1,0,3,2] row_mask:0xf bank_mask:0xf
    v_fmac_f32_dpp v89, v84, v169 quad_perm:[1,0,3,2] row_mask:0xf bank_mask:0xf
    v_fmac_f32_dpp v90, v85, v170 quad_perm:[1,0,3,2] row_mask:0xf bank_mask:0xf
    v_fmac_f32_dpp v91, v86, v171 quad_perm:[1,0,3,2] row_mask:0xf bank_mask:0xf
    v_fma_f32 v82, v162, v87, v49
    v_fma_f32 v83, v163, v88, v57
    v_fma_f32 v84, v164, v89, v65
    v_fma_f32 v85, v165, v90, v73
    v_fma_f32 v86, v166, v91, v81
    v_fmac_f32_dpp v82, v87, v167 quad_perm:[1,0,3,2] row_mask:0xf bank_mask:0xf
    v_fmac_f32_dpp v83, v88, v168 quad_perm:[1,0,3,2] row_mask:0xf bank_mask:0xf
    v_fmac_f32_dpp v84, v89, v169 quad_perm:[1,0,3,2] row_mask:0xf bank_mask:0xf
    v_fmac_f32_dpp v85, v90, v170 quad_perm:[1,0,3,2] row_mask:0xf bank_mask:0xf
    v_fmac_f32_dpp v86, v91, v171 quad_perm:[1,0,3,2] row_mask:0xf bank_mask:0xf
    v_mov_b32 v87, v82
    v_mov_b32 v88, v83
    v_mov_b32 v89, v84
    v_mov_b32 v90, v85
    v_mov_b32 v91, v86
    v_permlane16_swap_b32 v82, v87
    v_permlane16_swap_b32 v83, v88
    v_permlane16_swap_b32 v84, v89
    v_permlane16_swap_b32 v85, v90
    v_permlane16_swap_b32 v86, v91
    v_fma_f32 v92, v182, v82, v87
    v_fma_f32 v93, v183, v83, v88
    v_fma_f32 v94, v184, v84, v89
    v_fma_f32 v95, v185, v85, v90
    v_fma_f32 v96, v186, v86, v91
    v_fmac_f32_dpp v92, v82, v187 quad_perm:[1,0,3,2] row_mask:0xf bank_mask:0xf
    v_fmac_f32_dpp v93, v83, v188 quad_perm:[1,0,3,2] row_mask:0xf bank_mask:0xf
    v_fmac_f32_dpp v94, v84, v189 quad_perm:[1,0,3,2] row_mask:0xf bank_mask:0xf
    v_fmac_f32_dpp v95, v85, v190 quad_perm:[1,0,3,2] row_mask:0xf bank_mask:0xf
    v_fmac_f32_dpp v96, v86, v191 quad_perm:[1,0,3,2] row_mask:0xf bank_mask:0xf
    v_mov_b32 v97, v92
    v_mov_b32 v98, v93
    v_mov_b32 v99, v94
    v_mov_b32 v100, v95
    v_mov_b32 v101, v96
    v_permlane32_swap_b32 v92, v97
    v_permlane32_swap_b32 v93, v98
    v_permlane32_swap_b32 v94, v99
    v_permlane32_swap_b32 v95, v100
    v_permlane32_swap_b32 v96, v101
    v_fma_f32 v102, v192, v92, v97
    v_fma_f32 v103, v193, v93, v98
    v_fma_f32 v104, v194, v94, v99
    v_fma_f32 v105, v195, v95, v100
    v_fma_f32 v106, v196, v96, v101
    v_fmac_f32_dpp v102, v92, v197 quad_perm:[1,0,3,2] row_mask:0xf bank_mask:0xf
    v_fmac_f32_dpp v103, v93, v198 quad_perm:[1,0,3,2] row_mask:0xf bank_mask:0xf
    v_fmac_f32_dpp v104, v94, v199 quad_perm:[1,0,3,2] row_mask:0xf bank_mask:0xf
    v_fmac_f32_dpp v105, v95, v200 quad_perm:[1,0,3,2] row_mask:0xf bank_mask:0xf
    v_fmac_f32_dpp v106, v96, v201 quad_perm:[1,0,3,2] row_mask:0xf bank_mask:0xf
    ds_write_b32 v25, v102 offset:0
    ds_write_b32 v25, v103 offset:256
    ds_write_b32 v25, v104 offset:512
    ds_write_b32 v25, v105 offset:768
    ds_write_b32 v25, v106 offset:1024
    ds_write_b32 v27, v28
    v_cndmask_b32 v87, 0, v92, s[10:11]
    v_cndmask_b32 v88, 0, v93, s[10:11]
    v_cndmask_b32 v89, 0, v94, s[10:11]
    v_cndmask_b32 v90, 0, v95, s[10:11]
    v_cndmask_b32 v91, 0, v96, s[10:11]
    v_fma_f32 v97, v182, v87, v82
    v_fma_f32 v98, v183, v88, v83
    v_fma_f32 v99, v184, v89, v84
    v_fma_f32 v100, v185, v90, v85
    v_fma_f32 v101, v186, v91, v86
    v_fmac_f32_dpp v97, v87, v187 quad_perm:[1,0,3,2] row_mask:0xf bank_mask:0xf
    v_fmac_f32_dpp v98, v88, v188 quad_perm:[1,0,3,2] row_mask:0xf bank_mask:0xf
    v_fmac_f32_dpp v99, v89, v189 quad_perm:[1,0,3,2] row_mask:0xf bank_mask:0xf
    v_fmac_f32_dpp v100, v90, v190 quad_perm:[1,0,3,2] row_mask:0xf bank_mask:0xf
    v_fmac_f32_dpp v101, v91, v191 quad_perm:[1,0,3,2] row_mask:0xf bank_mask:0xf
    v_cndmask_b32 v10, v87, v97, s[12:13]
    v_cndmask_b32 v11, v88, v98, s[12:13]
    v_cndmask_b32 v12, v89, v99, s[12:13]
    v_cndmask_b32 v13, v90, v100, s[12:13]
    v_cndmask_b32 v14, v91, v101, s[12:13]
    s_mov_b32 s3, 131072
L_lw_36:
    ds_read_b128 v[38:41], v26 offset:0
    ds_read_b128 v[110:113], v24 offset:0
    ds_read_b128 v[114:117], v24 offset:256
    ds_read_b128 v[118:121], v24 offset:512
    ds_read_b128 v[122:125], v24 offset:768
    ds_read_b128 v[126:129], v24 offset:1024
    s_sub_u32 s3, s3, 1
    s_cbranch_scc1 L_lok_37
    s_waitcnt lgkmcnt(5)
    v_and_b32 v38, v38, v39
    v_and_b32 v40, v40, v41
    v_and_b32 v38, v38, v40
    v_cmp_ne_u32 vcc, -1, v38
    s_nop 1
    s_cmp_lg_u64 vcc, 0
    s_cbranch_scc1 L_lw_36
L_lok_37:
    s_waitcnt lgkmcnt(0)
    v_fma_f32 v138, v202, v110, v111
    v_fma_f32 v139, v203, v114, v115
    v_fma_f32 v140, v204, v118, v119
    v_fma_f32 v141, v205, v122, v123
    v_fma_f32 v142, v206, v126, v127
    v_fmac_f32_dpp v138, v110, v207 quad_perm:[1,0,3,2] row_mask:0xf bank_mask:0xf
    v_fmac_f32_dpp v139, v114, v208 quad_perm:[1,0,3,2] row_mask:0xf bank_mask:0xf
    v_fmac_f32_dpp v140, v118, v209 quad_perm:[1,0,3,2] row_mask:0xf bank_mask:0xf
    v_fmac_f32_dpp v141, v122, v210 quad_perm:[1,0,3,2] row_mask:0xf bank_mask:0xf
    v_fmac_f32_dpp v142, v126, v211 quad_perm:[1,0,3,2] row_mask:0xf bank_mask:0xf
    v_fma_f32 v143, v202, v138, v112
    v_fma_f32 v144, v203, v139, v116
    v_fma_f32 v145, v204, v140, v120
    v_fma_f32 v146, v205, v141, v124
    v_fma_f32 v147, v206, v142, v128
    v_fmac_f32_dpp v143, v138, v207 quad_perm:[1,0,3,2] row_mask:0xf bank_mask:0xf
    v_fmac_f32_dpp v144, v139, v208 quad_perm:[1,0,3,2] row_mask:0xf bank_mask:0xf
    v_fmac_f32_dpp v145, v140, v209 quad_perm:[1,0,3,2] row_mask:0xf bank_mask:0xf
    v_fmac_f32_dpp v146, v141, v210 quad_perm:[1,0,3,2] row_mask:0xf bank_mask:0xf
    v_fmac_f32_dpp v147, v142, v211 quad_perm:[1,0,3,2] row_mask:0xf bank_mask:0xf
    v_fma_f32 v148, v202, v143, v113
    v_fma_f32 v149, v203, v144, v117
    v_fma_f32 v150, v204, v145, v121
    v_fma_f32 v151, v205, v146, v125
    v_fma_f32 v156, v206, v147, v129
    v_fmac_f32_dpp v148, v143, v207 quad_perm:[1,0,3,2] row_mask:0xf bank_mask:0xf
    v_fmac_f32_dpp v149, v144, v208 quad_perm:[1,0,3,2] row_mask:0xf bank_mask:0xf
    v_fmac_f32_dpp v150, v145, v209 quad_perm:[1,0,3,2] row_mask:0xf bank_mask:0xf
    v_fmac_f32_dpp v151, v146, v210 quad_perm:[1,0,3,2] row_mask:0xf bank_mask:0xf
    v_fmac_f32_dpp v156, v147, v211 quad_perm:[1,0,3,2] row_mask:0xf bank_mask:0xf
    v_cndmask_b32 v154, v148, v149, s[4:5]
    v_cndmask_b32 v154, v154, v150, s[6:7]
    v_cndmask_b32 v154, v154, v151, s[8:9]
    buffer_store_dwordx2 v[154:155], v29, s[40:43], s75 offen sc1
    s_mov_b64 exec, 0xffff
    buffer_store_dwordx2 v[156:157], v29, s[40:43], s75 offen offset:512 sc1
    s_mov_b64 exec, -1
    s_mul_i32 s50, s48, 1280
    s_add_u32 s50, s50, 147840
    v_lshl_add_u32 v38, v1, 2, s50
    ds_read_b32 v15, v38 offset:0
    ds_read_b32 v16, v38 offset:256
    ds_read_b32 v17, v38 offset:512
    ds_read_b32 v18, v38 offset:768
    ds_read_b32 v19, v38 offset:1024
    s_mov_b32 s60, s28
    s_mov_b32 s61, s29
    s_mov_b32 s62, 0x1e0000
    s_mov_b32 s63, 0x20000
    s_mul_i32 s80, s48, 7680
    s_setprio 0
    v_cndmask_b32 v102, 0, v110, s[36:37]
    v_cndmask_b32 v103, 0, v114, s[36:37]
    v_cndmask_b32 v104, 0, v118, s[36:37]
    v_cndmask_b32 v105, 0, v122, s[36:37]
    v_cndmask_b32 v106, 0, v126, s[36:37]
    v_cndmask_b32 v102, v102, v138, s[22:23]
    v_cndmask_b32 v103, v103, v139, s[22:23]
    v_cndmask_b32 v104, v104, v140, s[22:23]
    v_cndmask_b32 v105, v105, v141, s[22:23]
    v_cndmask_b32 v106, v106, v142, s[22:23]
    v_cndmask_b32 v102, v102, v143, s[26:27]
    v_cndmask_b32 v103, v103, v144, s[26:27]
    v_cndmask_b32 v104, v104, v145, s[26:27]
    v_cndmask_b32 v105, v105, v146, s[26:27]
    v_cndmask_b32 v106, v106, v147, s[26:27]
    s_waitcnt lgkmcnt(0)
    s_add_u32 s76, s47, 3
    s_and_b32 s76, s76, 3
    s_lshl2_add_u32 s76, s46, s76
    s_lshl2_add_u32 s76, s76, s48
    s_mul_i32 s76, s76, 30720
    s_mul_i32 s77, s47, 320
    s_add_u32 s76, s76, s77
    s_add_u32 s77, s76, 20480
    s_add_u32 m0, s80, 30720
    s_nop 0
    buffer_load_dwordx4 v15, s[60:63], s76 offen lds
    v_lshrrev_b32 v39, 4, v1
    v_cvt_f32_u32 v40, v20
    v_cvt_f32_u32 v39, v39
    v_mul_f32 v40, 0x41000000, v40
    v_mul_f32 v39, 0x41000000, v39
    v_mul_f32 v41, 0x41800000, v40
    v_mul_f32 v138, v39, v212
    v_mul_f32 v139, v39, v213
    v_mul_f32 v140, v39, v214
    v_mul_f32 v141, v39, v215
    v_mul_f32 v142, v39, v216
    v_mul_f32 v143, v39, v217
    v_mul_f32 v144, v39, v218
    v_mul_f32 v145, v39, v219
    v_mul_f32 v146, v39, v220
    v_mul_f32 v147, v39, v221
    v_exp_f32 v138, v138
    s_add_u32 m0, s80, 31744
    s_nop 0
    buffer_load_dwordx4 v16, s[60:63], s76 offen lds
    v_exp_f32 v139, v139
    v_exp_f32 v140, v140
    v_exp_f32 v141, v141
    v_exp_f32 v142, v142
    v_fract_f32 v143, v143
    v_fract_f32 v144, v144
    v_fract_f32 v145, v145
    v_fract_f32 v146, v146
    v_fract_f32 v147, v147
    v_cos_f32 v148, v143
    v_cos_f32 v149, v144
    v_cos_f32 v150, v145
    v_cos_f32 v151, v146
    v_cos_f32 v152, v147
    v_sin_f32 v143, v143
    v_sin_f32 v144, v144
    v_sin_f32 v145, v145
    s_add_u32 m0, s80, 32768
    s_nop 0
    buffer_load_dwordx4 v17, s[60:63], s76 offen lds
    v_sin_f32 v146, v146
    v_sin_f32 v147, v147
    v_mul_f32 v222, v138, v148
    v_mul_f32 v223, v139, v149
    v_mul_f32 v224, v140, v150
    v_mul_f32 v225, v141, v151
    v_mul_f32 v226, v142, v152
    v_mul_f32 v138, v21, v138
    v_mul_f32 v139, v21, v139
    v_mul_f32 v140, v21, v140
    v_mul_f32 v141, v21, v141
    v_mul_f32 v142, v21, v142
    v_mul_f32 v227, v138, v143
    v_mul_f32 v228, v139, v144
    v_mul_f32 v229, v140, v145
    v_mul_f32 v230, v141, v146
    v_mul_f32 v231, v142, v147
    s_add_u32 m0, s80, 33792
    s_nop 0
    buffer_load_dwordx4 v18, s[60:63], s76 offen lds
    v_mul_f32 v138, v40, v212
    v_mul_f32 v139, v40, v213
    v_mul_f32 v140, v40, v214
    v_mul_f32 v141, v40, v215
    v_mul_f32 v142, v40, v216
    v_mul_f32 v143, v40, v217
    v_mul_f32 v144, v40, v218
    v_mul_f32 v145, v40, v219
    v_mul_f32 v146, v40, v220
    v_mul_f32 v147, v40, v221
    v_exp_f32 v138, v138
    v_exp_f32 v139, v139
    v_exp_f32 v140, v140
    v_exp_f32 v141, v141
    v_exp_f32 v142, v142
    v_fract_f32 v143, v143
    v_fract_f32 v144, v144
    s_add_u32 m0, s80, 34816
    s_nop 0
    buffer_load_dwordx4 v19, s[60:63], s76 offen lds
    v_fract_f32 v145, v145
    v_fract_f32 v146, v146
    v_fract_f32 v147, v147
    v_cos_f32 v148, v143
    v_cos_f32 v149, v144
    v_cos_f32 v150, v145
    v_cos_f32 v151, v146
    v_cos_f32 v152, v147
    v_sin_f32 v143, v143
    v_sin_f32 v144, v144
    v_sin_f32 v145, v145
    v_sin_f32 v146, v146
    v_sin_f32 v147, v147
    v_mul_f32 v232, v138, v148
    v_mul_f32 v233, v139, v149
    v_mul_f32 v234, v140, v150
    v_mul_f32 v235, v141, v151
    s_add_u32 m0, s80, 35840
    s_nop 0
    buffer_load_dwordx4 v15, s[60:63], s77 offen lds
    v_mul_f32 v236, v142, v152
    v_mul_f32 v138, v21, v138
    v_mul_f32 v139, v21, v139
    v_mul_f32 v140, v21, v140
    v_mul_f32 v141, v21, v141
    v_mul_f32 v142, v21, v142
    v_mul_f32 v237, v138, v143
    v_mul_f32 v238, v139, v144
    v_mul_f32 v239, v140, v145
    v_mul_f32 v240, v141, v146
    v_mul_f32 v241, v142, v147
    v_mul_f32 v138, v41, v212
    v_mul_f32 v139, v41, v213
    v_mul_f32 v140, v41, v214
    v_mul_f32 v141, v41, v215
    v_mul_f32 v142, v41, v216
    v_mul_f32 v143, v41, v217
    s_add_u32 m0, s80, 36864
    s_nop 0
    buffer_load_dwordx4 v16, s[60:63], s77 offen lds
    v_mul_f32 v144, v41, v218
    v_mul_f32 v145, v41, v219
    v_mul_f32 v146, v41, v220
    v_mul_f32 v147, v41, v221
    v_exp_f32 v138, v138
    v_exp_f32 v139, v139
    v_exp_f32 v140, v140
    v_exp_f32 v141, v141
    v_exp_f32 v142, v142
    v_fract_f32 v143, v143
    v_fract_f32 v144, v144
    v_fract_f32 v145, v145
    v_fract_f32 v146, v146
    v_fract_f32 v147, v147
    v_cos_f32 v148, v143
    v_cos_f32 v149, v144
    v_cos_f32 v150, v145
    s_add_u32 m0, s80, 37888
    s_mov_b32 exec_hi, 0
    buffer_load_dwordx4 v17, s[60:63], s77 offen lds
    s_mov_b32 exec_hi, -1
    v_cos_f32 v151, v146
    v_cos_f32 v152, v147
    v_sin_f32 v143, v143
    v_sin_f32 v144, v144
    v_sin_f32 v145, v145
    v_sin_f32 v146, v146
    v_sin_f32 v147, v147
    v_mul_f32 v242, v138, v148
    v_mul_f32 v243, v139, v149
    v_mul_f32 v244, v140, v150
    v_mul_f32 v245, v141, v151
    v_mul_f32 v246, v142, v152
    v_mul_f32 v138, v21, v138
    v_mul_f32 v139, v21, v139
    v_mul_f32 v140, v21, v140
    v_mul_f32 v141, v21, v141
    v_mul_f32 v142, v21, v142
    v_mul_f32 v247, v138, v143
    v_mul_f32 v248, v139, v144
    v_mul_f32 v249, v140, v145
    v_mul_f32 v250, v141, v146
    v_mul_f32 v251, v142, v147
    v_fma_f32 v10, v222, v102, v10
    v_fma_f32 v11, v223, v103, v11
    v_fma_f32 v12, v224, v104, v12
    v_fma_f32 v13, v225, v105, v13
    v_fma_f32 v14, v226, v106, v14
    v_fmac_f32_dpp v10, v102, v227 quad_perm:[1,0,3,2] row_mask:0xf bank_mask:0xf
    v_fmac_f32_dpp v11, v103, v228 quad_perm:[1,0,3,2] row_mask:0xf bank_mask:0xf
    v_fmac_f32_dpp v12, v104, v229 quad_perm:[1,0,3,2] row_mask:0xf bank_mask:0xf
    v_fmac_f32_dpp v13, v105, v230 quad_perm:[1,0,3,2] row_mask:0xf bank_mask:0xf
    v_fmac_f32_dpp v14, v106, v231 quad_perm:[1,0,3,2] row_mask:0xf bank_mask:0xf
    buffer_load_dwordx2 v[138:139], v30, s[40:43], 0 offen offset:0 sc1
    buffer_load_dwordx2 v[140:141], v30, s[40:43], 0 offen offset:128 sc1
    buffer_load_dwordx2 v[142:143], v30, s[40:43], 0 offen offset:256 sc1
    buffer_load_dwordx2 v[144:145], v30, s[40:43], 0 offen offset:384 sc1
    buffer_load_dwordx2 v[146:147], v30, s[40:43], 0 offen offset:512 sc1
    v_mul_f32_dpp v97, v42, v177 quad_perm:[1,0,3,2] row_mask:0xf bank_mask:0xf
    v_mul_f32_dpp v98, v50, v178 quad_perm:[1,0,3,2] row_mask:0xf bank_mask:0xf
    v_mul_f32_dpp v99, v58, v179 quad_perm:[1,0,3,2] row_mask:0xf bank_mask:0xf
    v_mul_f32_dpp v100, v66, v180 quad_perm:[1,0,3,2] row_mask:0xf bank_mask:0xf
    v_mul_f32_dpp v101, v74, v181 quad_perm:[1,0,3,2] row_mask:0xf bank_mask:0xf
    v_fma_f32 v42, v172, v42, v97
    v_fma_f32 v50, v173, v50, v98
    v_fma_f32 v58, v174, v58, v99
    v_fma_f32 v66, v175, v66, v100
    v_fma_f32 v74, v176, v74, v101
    v_mul_f32_dpp v87, v43, v177 quad_perm:[1,0,3,2] row_mask:0xf bank_mask:0xf
    v_mul_f32_dpp v88, v51, v178 quad_perm:[1,0,3,2] row_mask:0xf bank_mask:0xf
    v_mul_f32_dpp v89, v59, v179 quad_perm:[1,0,3,2] row_mask:0xf bank_mask:0xf
    v_mul_f32_dpp v90, v67, v180 quad_perm:[1,0,3,2] row_mask:0xf bank_mask:0xf
    v_mul_f32_dpp v91, v75, v181 quad_perm:[1,0,3,2] row_mask:0xf bank_mask:0xf
    v_fma_f32 v43, v172, v43, v87
    v_fma_f32 v51, v173, v51, v88
    v_fma_f32 v59, v174, v59, v89
    v_fma_f32 v67, v175, v67, v90
    v_fma_f32 v75, v176, v75, v91
    v_mul_f32_dpp v97, v44, v177 quad_perm:[1,0,3,2] row_mask:0xf bank_mask:0xf
    v_mul_f32_dpp v98, v52, v178 quad_perm:[1,0,3,2] row_mask:0xf bank_mask:0xf
    v_mul_f32_dpp v99, v60, v179 quad_perm:[1,0,3,2] row_mask:0xf bank_mask:0xf
    v_mul_f32_dpp v100, v68, v180 quad_perm:[1,0,3,2] row_mask:0xf bank_mask:0xf
    v_mul_f32_dpp v101, v76, v181 quad_perm:[1,0,3,2] row_mask:0xf bank_mask:0xf
    v_fma_f32 v44, v172, v44, v97
    v_fma_f32 v52, v173, v52, v98
    v_fma_f32 v60, v174, v60, v99
    v_fma_f32 v68, v175, v68, v100
    v_fma_f32 v76, v176, v76, v101
    v_mul_f32_dpp v87, v45, v177 quad_perm:[1,0,3,2] row_mask:0xf bank_mask:0xf
    v_mul_f32_dpp v88, v53, v178 quad_perm:[1,0,3,2] row_mask:0xf bank_mask:0xf
    v_mul_f32_dpp v89, v61, v179 quad_perm:[1,0,3,2] row_mask:0xf bank_mask:0xf
    v_mul_f32_dpp v90, v69, v180 quad_perm:[1,0,3,2] row_mask:0xf bank_mask:0xf
    v_mul_f32_dpp v91, v77, v181 quad_perm:[1,0,3,2] row_mask:0xf bank_mask:0xf
    v_fma_f32 v45, v172, v45, v87
    v_fma_f32 v53, v173, v53, v88
    v_fma_f32 v61, v174, v61, v89
    v_fma_f32 v69, v175, v69, v90
    v_fma_f32 v77, v176, v77, v91
    v_mul_f32_dpp v97, v46, v177 quad_perm:[1,0,3,2] row_mask:0xf bank_mask:0xf
    v_mul_f32_dpp v98, v54, v178 quad_perm:[1,0,3,2] row_mask:0xf bank_mask:0xf
    v_mul_f32_dpp v99, v62, v179 quad_perm:[1,0,3,2] row_mask:0xf bank_mask:0xf
    v_mul_f32_dpp v100, v70, v180 quad_perm:[1,0,3,2] row_mask:0xf bank_mask:0xf
    v_mul_f32_dpp v101, v78, v181 quad_perm:[1,0,3,2] row_mask:0xf bank_mask:0xf
    v_fma_f32 v46, v172, v46, v97
    v_fma_f32 v54, v173, v54, v98
    v_fma_f32 v62, v174, v62, v99
    v_fma_f32 v70, v175, v70, v100
    v_fma_f32 v78, v176, v78, v101
    v_mul_f32_dpp v87, v47, v177 quad_perm:[1,0,3,2] row_mask:0xf bank_mask:0xf
    v_mul_f32_dpp v88, v55, v178 quad_perm:[1,0,3,2] row_mask:0xf bank_mask:0xf
    v_mul_f32_dpp v89, v63, v179 quad_perm:[1,0,3,2] row_mask:0xf bank_mask:0xf
    v_mul_f32_dpp v90, v71, v180 quad_perm:[1,0,3,2] row_mask:0xf bank_mask:0xf
    v_mul_f32_dpp v91, v79, v181 quad_perm:[1,0,3,2] row_mask:0xf bank_mask:0xf
    v_fma_f32 v47, v172, v47, v87
    v_fma_f32 v55, v173, v55, v88
    v_fma_f32 v63, v174, v63, v89
    v_fma_f32 v71, v175, v71, v90
    v_fma_f32 v79, v176, v79, v91
    v_mul_f32_dpp v97, v48, v177 quad_perm:[1,0,3,2] row_mask:0xf bank_mask:0xf
    v_mul_f32_dpp v98, v56, v178 quad_perm:[1,0,3,2] row_mask:0xf bank_mask:0xf
    v_mul_f32_dpp v99, v64, v179 quad_perm:[1,0,3,2] row_mask:0xf bank_mask:0xf
    v_mul_f32_dpp v100, v72, v180 quad_perm:[1,0,3,2] row_mask:0xf bank_mask:0xf
    v_mul_f32_dpp v101, v80, v181 quad_perm:[1,0,3,2] row_mask:0xf bank_mask:0xf
    v_fma_f32 v48, v172, v48, v97
    v_fma_f32 v56, v173, v56, v98
    v_fma_f32 v64, v174, v64, v99
    v_fma_f32 v72, v175, v72, v100
    v_fma_f32 v80, v176, v80, v101
    v_mul_f32_dpp v87, v49, v177 quad_perm:[1,0,3,2] row_mask:0xf bank_mask:0xf
    v_mul_f32_dpp v88, v57, v178 quad_perm:[1,0,3,2] row_mask:0xf bank_mask:0xf
    v_mul_f32_dpp v89, v65, v179 quad_perm:[1,0,3,2] row_mask:0xf bank_mask:0xf
    v_mul_f32_dpp v90, v73, v180 quad_perm:[1,0,3,2] row_mask:0xf bank_mask:0xf
    v_mul_f32_dpp v91, v81, v181 quad_perm:[1,0,3,2] row_mask:0xf bank_mask:0xf
    v_fma_f32 v49, v172, v49, v87
    v_fma_f32 v57, v173, v57, v88
    v_fma_f32 v65, v174, v65, v89
    v_fma_f32 v73, v175, v73, v90
    v_fma_f32 v81, v176, v81, v91
    s_mov_b32 s3, 131072
L_gw_38:
    ds_read_b128 v[38:41], v26 offset:48
    s_sub_u32 s3, s3, 1
    s_waitcnt lgkmcnt(0)
    s_cbranch_scc1 L_gwok_39
    v_min3_u32 v38, v38, v39, v40
    v_min_u32 v38, v38, v41
    v_cmp_gt_u32 vcc, 1, v38
    s_nop 1
    s_cmp_lg_u64 vcc, 0
    s_cbranch_scc0 L_gwok_39
    s_sleep 2
    s_branch L_gw_38
L_gwok_39:
    ds_read_b128 v[130:133], v31 offset:0
    ds_read_b128 v[134:137], v31 offset:16
    s_setprio 3
    s_mov_b32 s3, 16384
    s_waitcnt vmcnt(0)
L_cp_40:
    v_xor_b32 v82, s49, v139
    v_xor_b32 v83, s49, v141
    v_xor_b32 v84, s49, v143
    v_xor_b32 v85, s49, v145
    v_xor_b32 v86, s49, v147
    v_or3_b32 v82, v82, v83, v84
    v_or3_b32 v82, v82, v85, v86
    v_cmp_ne_u32 vcc, 0, v82
    s_nop 1
    s_andn2_b64 vcc, vcc, s[18:19]
    s_cbranch_scc0 L_cok_41
    s_sleep 2
    buffer_load_dwordx2 v[138:139], v30, s[40:43], 0 offen offset:0 sc1
    buffer_load_dwordx2 v[140:141], v30, s[40:43], 0 offen offset:128 sc1
    buffer_load_dwordx2 v[142:143], v30, s[40:43], 0 offen offset:256 sc1
    buffer_load_dwordx2 v[144:145], v30, s[40:43], 0 offen offset:384 sc1
    buffer_load_dwordx2 v[146:147], v30, s[40:43], 0 offen offset:512 sc1
    s_sub_u32 s3, s3, 1
    s_waitcnt vmcnt(0)
    s_cbranch_scc0 L_cp_40
L_cok_41:
    v_mov_b32 v23, 1
    ds_write_b32 v27, v23 offset:32
    v_mul_f32 v82, v242, v138
    v_mul_f32 v83, v243, v140
    v_mul_f32 v84, v244, v142
    v_mul_f32 v85, v245, v144
    v_mul_f32 v86, v246, v146
    v_fmac_f32_dpp v82, v138, v247 quad_perm:[1,0,3,2] row_mask:0xf bank_mask:0xf
    v_fmac_f32_dpp v83, v140, v248 quad_perm:[1,0,3,2] row_mask:0xf bank_mask:0xf
    v_fmac_f32_dpp v84, v142, v249 quad_perm:[1,0,3,2] row_mask:0xf bank_mask:0xf
    v_fmac_f32_dpp v85, v144, v250 quad_perm:[1,0,3,2] row_mask:0xf bank_mask:0xf
    v_fmac_f32_dpp v86, v146, v251 quad_perm:[1,0,3,2] row_mask:0xf bank_mask:0xf
    v_mov_b32 v87, v82
    v_mov_b32 v88, v83
    v_mov_b32 v89, v84
    v_mov_b32 v90, v85
    v_mov_b32 v91, v86
    v_permlane16_swap_b32 v82, v87
    v_permlane16_swap_b32 v83, v88
    v_permlane16_swap_b32 v84, v89
    v_permlane16_swap_b32 v85, v90
    v_permlane16_swap_b32 v86, v91
    v_add_f32 v82, v82, v87
    v_add_f32 v83, v83, v88
    v_add_f32 v84, v84, v89
    v_add_f32 v85, v85, v90
    v_add_f32 v86, v86, v91
    v_mov_b32 v87, v82
    v_mov_b32 v88, v83
    v_mov_b32 v89, v84
    v_mov_b32 v90, v85
    v_mov_b32 v91, v86
    v_permlane32_swap_b32 v82, v87
    v_permlane32_swap_b32 v83, v88
    v_permlane32_swap_b32 v84, v89
    v_permlane32_swap_b32 v85, v90
    v_permlane32_swap_b32 v86, v91
    v_add_f32 v82, v82, v87
    v_add_f32 v83, v83, v88
    v_add_f32 v84, v84, v89
    v_add_f32 v85, v85, v90
    v_add_f32 v86, v86, v91
    ds_write_b32 v25, v82 offset:1280
    ds_write_b32 v25, v83 offset:1536
    ds_write_b32 v25, v84 offset:1792
    ds_write_b32 v25, v85 offset:2048
    ds_write_b32 v25, v86 offset:2304
    ds_write_b32 v27, v28 offset:16
    s_mov_b32 s3, 131072
L_lw_42:
    ds_read_b128 v[38:41], v26 offset:16
    ds_read_b128 v[110:113], v24 offset:1280
    ds_read_b128 v[114:117], v24 offset:1536
    ds_read_b128 v[118:121], v24 offset:1792
    ds_read_b128 v[122:125], v24 offset:2048
    ds_read_b128 v[126:129], v24 offset:2304
    s_sub_u32 s3, s3, 1
    s_cbranch_scc1 L_lok_43
    s_waitcnt lgkmcnt(5)
    v_and_b32 v38, v38, v39
    v_and_b32 v40, v40, v41
    v_and_b32 v38, v38, v40
    v_cmp_ne_u32 vcc, -1, v38
    s_nop 1
    s_cmp_lg_u64 vcc, 0
    s_cbranch_scc1 L_lw_42
L_lok_43:
    s_waitcnt lgkmcnt(0)
    v_pk_add_f32 v[110:111], v[110:111], v[112:113]
    v_pk_add_f32 v[114:115], v[114:115], v[116:117]
    v_pk_add_f32 v[118:119], v[118:119], v[120:121]
    v_pk_add_f32 v[122:123], v[122:123], v[124:125]
    v_pk_add_f32 v[126:127], v[126:127], v[128:129]
    v_add_f32 v82, v110, v111
    v_add_f32 v83, v114, v115
    v_add_f32 v84, v118, v119
    v_add_f32 v85, v122, v123
    v_add_f32 v86, v126, v127
    v_fma_f32 v10, v232, v82, v10
    v_fma_f32 v11, v233, v83, v11
    v_fma_f32 v12, v234, v84, v12
    v_fma_f32 v13, v235, v85, v13
    v_fma_f32 v14, v236, v86, v14
    v_fmac_f32_dpp v10, v82, v237 quad_perm:[1,0,3,2] row_mask:0xf bank_mask:0xf
    v_fmac_f32_dpp v11, v83, v238 quad_perm:[1,0,3,2] row_mask:0xf bank_mask:0xf
    v_fmac_f32_dpp v12, v84, v239 quad_perm:[1,0,3,2] row_mask:0xf bank_mask:0xf
    v_fmac_f32_dpp v13, v85, v240 quad_perm:[1,0,3,2] row_mask:0xf bank_mask:0xf
    v_fmac_f32_dpp v14, v86, v241 quad_perm:[1,0,3,2] row_mask:0xf bank_mask:0xf
    v_mul_f32 v87, v172, v10
    v_mul_f32 v88, v173, v11
    v_mul_f32 v89, v174, v12
    v_mul_f32 v90, v175, v13
    v_mul_f32 v91, v176, v14
    v_fmac_f32_dpp v87, v10, v177 quad_perm:[1,0,3,2] row_mask:0xf bank_mask:0xf
    v_fmac_f32_dpp v88, v11, v178 quad_perm:[1,0,3,2] row_mask:0xf bank_mask:0xf
    v_fmac_f32_dpp v89, v12, v179 quad_perm:[1,0,3,2] row_mask:0xf bank_mask:0xf
    v_fmac_f32_dpp v90, v13, v180 quad_perm:[1,0,3,2] row_mask:0xf bank_mask:0xf
    v_fmac_f32_dpp v91, v14, v181 quad_perm:[1,0,3,2] row_mask:0xf bank_mask:0xf
    v_fmac_f32 v42, v162, v87
    v_fmac_f32 v50, v163, v88
    v_fmac_f32 v58, v164, v89
    v_fmac_f32 v66, v165, v90
    v_fmac_f32 v74, v166, v91
    v_fmac_f32_dpp v42, -v87, v167 quad_perm:[1,0,3,2] row_mask:0xf bank_mask:0xf
    v_fmac_f32_dpp v50, -v88, v168 quad_perm:[1,0,3,2] row_mask:0xf bank_mask:0xf
    v_fmac_f32_dpp v58, -v89, v169 quad_perm:[1,0,3,2] row_mask:0xf bank_mask:0xf
    v_fmac_f32_dpp v66, -v90, v170 quad_perm:[1,0,3,2] row_mask:0xf bank_mask:0xf
    v_fmac_f32_dpp v74, -v91, v171 quad_perm:[1,0,3,2] row_mask:0xf bank_mask:0xf
    v_fmac_f32 v43, v162, v42
    v_fmac_f32 v51, v163, v50
    v_fmac_f32 v59, v164, v58
    v_fmac_f32 v67, v165, v66
    v_fmac_f32 v75, v166, v74
    v_fmac_f32_dpp v43, -v42, v167 quad_perm:[1,0,3,2] row_mask:0xf bank_mask:0xf
    v_fmac_f32_dpp v51, -v50, v168 quad_perm:[1,0,3,2] row_mask:0xf bank_mask:0xf
    v_fmac_f32_dpp v59, -v58, v169 quad_perm:[1,0,3,2] row_mask:0xf bank_mask:0xf
    v_fmac_f32_dpp v67, -v66, v170 quad_perm:[1,0,3,2] row_mask:0xf bank_mask:0xf
    v_fmac_f32_dpp v75, -v74, v171 quad_perm:[1,0,3,2] row_mask:0xf bank_mask:0xf
    v_pk_mul_f32 v[92:93], v[42:43], v[130:131]
    v_pk_mul_f32 v[94:95], v[50:51], v[130:131]
    v_pk_mul_f32 v[96:97], v[58:59], v[130:131]
    v_pk_mul_f32 v[98:99], v[66:67], v[130:131]
    v_pk_mul_f32 v[100:101], v[74:75], v[130:131]
    v_cvt_pk_bf16_f32 v110, v92, v93
    v_cvt_pk_bf16_f32 v114, v94, v95
    v_cvt_pk_bf16_f32 v118, v96, v97
    v_cvt_pk_bf16_f32 v122, v98, v99
    v_cvt_pk_bf16_f32 v126, v100, v101
    v_fmac_f32 v44, v162, v43
    v_fmac_f32 v52, v163, v51
    v_fmac_f32 v60, v164, v59
    v_fmac_f32 v68, v165, v67
    v_fmac_f32 v76, v166, v75
    v_fmac_f32_dpp v44, -v43, v167 quad_perm:[1,0,3,2] row_mask:0xf bank_mask:0xf
    v_fmac_f32_dpp v52, -v51, v168 quad_perm:[1,0,3,2] row_mask:0xf bank_mask:0xf
    v_fmac_f32_dpp v60, -v59, v169 quad_perm:[1,0,3,2] row_mask:0xf bank_mask:0xf
    v_fmac_f32_dpp v68, -v67, v170 quad_perm:[1,0,3,2] row_mask:0xf bank_mask:0xf
    v_fmac_f32_dpp v76, -v75, v171 quad_perm:[1,0,3,2] row_mask:0xf bank_mask:0xf
    v_fmac_f32 v45, v162, v44
    v_fmac_f32 v53, v163, v52
    v_fmac_f32 v61, v164, v60
    v_fmac_f32 v69, v165, v68
    v_fmac_f32 v77, v166, v76
    v_fmac_f32_dpp v45, -v44, v167 quad_perm:[1,0,3,2] row_mask:0xf bank_mask:0xf
    v_fmac_f32_dpp v53, -v52, v168 quad_perm:[1,0,3,2] row_mask:0xf bank_mask:0xf
    v_fmac_f32_dpp v61, -v60, v169 quad_perm:[1,0,3,2] row_mask:0xf bank_mask:0xf
    v_fmac_f32_dpp v69, -v68, v170 quad_perm:[1,0,3,2] row_mask:0xf bank_mask:0xf
    v_fmac_f32_dpp v77, -v76, v171 quad_perm:[1,0,3,2] row_mask:0xf bank_mask:0xf
    v_pk_mul_f32 v[92:93], v[44:45], v[132:133]
    v_pk_mul_f32 v[94:95], v[52:53], v[132:133]
    v_pk_mul_f32 v[96:97], v[60:61], v[132:133]
    v_pk_mul_f32 v[98:99], v[68:69], v[132:133]
    v_pk_mul_f32 v[100:101], v[76:77], v[132:133]
    v_cvt_pk_bf16_f32 v111, v92, v93
    v_cvt_pk_bf16_f32 v115, v94, v95
    v_cvt_pk_bf16_f32 v119, v96, v97
    v_cvt_pk_bf16_f32 v123, v98, v99
    v_cvt_pk_bf16_f32 v127, v100, v101
    v_fmac_f32 v46, v162, v45
    v_fmac_f32 v54, v163, v53
    v_fmac_f32 v62, v164, v61
    v_fmac_f32 v70, v165, v69
    v_fmac_f32 v78, v166, v77
    v_fmac_f32_dpp v46, -v45, v167 quad_perm:[1,0,3,2] row_mask:0xf bank_mask:0xf
    v_fmac_f32_dpp v54, -v53, v168 quad_perm:[1,0,3,2] row_mask:0xf bank_mask:0xf
    v_fmac_f32_dpp v62, -v61, v169 quad_perm:[1,0,3,2] row_mask:0xf bank_mask:0xf
    v_fmac_f32_dpp v70, -v69, v170 quad_perm:[1,0,3,2] row_mask:0xf bank_mask:0xf
    v_fmac_f32_dpp v78, -v77, v171 quad_perm:[1,0,3,2] row_mask:0xf bank_mask:0xf
    v_fmac_f32 v47, v162, v46
    v_fmac_f32 v55, v163, v54
    v_fmac_f32 v63, v164, v62
    v_fmac_f32 v71, v165, v70
    v_fmac_f32 v79, v166, v78
    v_fmac_f32_dpp v47, -v46, v167 quad_perm:[1,0,3,2] row_mask:0xf bank_mask:0xf
    v_fmac_f32_dpp v55, -v54, v168 quad_perm:[1,0,3,2] row_mask:0xf bank_mask:0xf
    v_fmac_f32_dpp v63, -v62, v169 quad_perm:[1,0,3,2] row_mask:0xf bank_mask:0xf
    v_fmac_f32_dpp v71, -v70, v170 quad_perm:[1,0,3,2] row_mask:0xf bank_mask:0xf
    v_fmac_f32_dpp v79, -v78, v171 quad_perm:[1,0,3,2] row_mask:0xf bank_mask:0xf
    v_pk_mul_f32 v[92:93], v[46:47], v[134:135]
    v_pk_mul_f32 v[94:95], v[54:55], v[134:135]
    v_pk_mul_f32 v[96:97], v[62:63], v[134:135]
    v_pk_mul_f32 v[98:99], v[70:71], v[134:135]
    v_pk_mul_f32 v[100:101], v[78:79], v[134:135]
    v_cvt_pk_bf16_f32 v112, v92, v93
    v_cvt_pk_bf16_f32 v116, v94, v95
    v_cvt_pk_bf16_f32 v120, v96, v97
    v_cvt_pk_bf16_f32 v124, v98, v99
    v_cvt_pk_bf16_f32 v128, v100, v101
    v_fmac_f32 v48, v162, v47
    v_fmac_f32 v56, v163, v55
    v_fmac_f32 v64, v164, v63
    v_fmac_f32 v72, v165, v71
    v_fmac_f32 v80, v166, v79
    v_fmac_f32_dpp v48, -v47, v167 quad_perm:[1,0,3,2] row_mask:0xf bank_mask:0xf
    v_fmac_f32_dpp v56, -v55, v168 quad_perm:[1,0,3,2] row_mask:0xf bank_mask:0xf
    v_fmac_f32_dpp v64, -v63, v169 quad_perm:[1,0,3,2] row_mask:0xf bank_mask:0xf
    v_fmac_f32_dpp v72, -v71, v170 quad_perm:[1,0,3,2] row_mask:0xf bank_mask:0xf
    v_fmac_f32_dpp v80, -v79, v171 quad_perm:[1,0,3,2] row_mask:0xf bank_mask:0xf
    v_fmac_f32 v49, v162, v48
    v_fmac_f32 v57, v163, v56
    v_fmac_f32 v65, v164, v64
    v_fmac_f32 v73, v165, v72
    v_fmac_f32 v81, v166, v80
    v_fmac_f32_dpp v49, -v48, v167 quad_perm:[1,0,3,2] row_mask:0xf bank_mask:0xf
    v_fmac_f32_dpp v57, -v56, v168 quad_perm:[1,0,3,2] row_mask:0xf bank_mask:0xf
    v_fmac_f32_dpp v65, -v64, v169 quad_perm:[1,0,3,2] row_mask:0xf bank_mask:0xf
    v_fmac_f32_dpp v73, -v72, v170 quad_perm:[1,0,3,2] row_mask:0xf bank_mask:0xf
    v_fmac_f32_dpp v81, -v80, v171 quad_perm:[1,0,3,2] row_mask:0xf bank_mask:0xf
    v_pk_mul_f32 v[92:93], v[48:49], v[136:137]
    v_pk_mul_f32 v[94:95], v[56:57], v[136:137]
    v_pk_mul_f32 v[96:97], v[64:65], v[136:137]
    v_pk_mul_f32 v[98:99], v[72:73], v[136:137]
    v_pk_mul_f32 v[100:101], v[80:81], v[136:137]
    v_cvt_pk_bf16_f32 v113, v92, v93
    ds_write_b128 v34, v[110:113] offset:0
    v_cvt_pk_bf16_f32 v117, v94, v95
    ds_write_b128 v34, v[114:117] offset:1280
    v_cvt_pk_bf16_f32 v121, v96, v97
    ds_write_b128 v34, v[118:121] offset:2560
    v_cvt_pk_bf16_f32 v125, v98, v99
    ds_write_b128 v34, v[122:125] offset:3840
    v_cvt_pk_bf16_f32 v129, v100, v101
    ds_write_b128 v34, v[126:129] offset:5120
    v_mov_b32 v23, 2
    ds_write_b32 v27, v23 offset:32
    s_waitcnt lgkmcnt(9)
    ds_read_b64_tr_b16 v[42:43], v35 offset:0
    ds_read_b64_tr_b16 v[44:45], v35 offset:640
    ds_read_b64_tr_b16 v[46:47], v35 offset:1280
    ds_read_b64_tr_b16 v[48:49], v35 offset:1920
    ds_read_b64_tr_b16 v[50:51], v35 offset:2560
    ds_read_b64_tr_b16 v[52:53], v35 offset:3200
    s_waitcnt lgkmcnt(9)
    ds_read_b64_tr_b16 v[54:55], v35 offset:3840
    ds_read_b64_tr_b16 v[56:57], v35 offset:4480
    ds_read_b64_tr_b16 v[58:59], v35 offset:5120
    ds_read_b64_tr_b16 v[60:61], v35 offset:5760
    s_waitcnt lgkmcnt(8)
    buffer_store_dwordx4 v[42:45], v36, s[40:43], s78 offen offset:0 sc1
    s_waitcnt lgkmcnt(6)
    buffer_store_dwordx4 v[46:49], v36, s[40:43], s78 offen offset:512 sc1
    s_waitcnt lgkmcnt(4)
    buffer_store_dwordx4 v[50:53], v36, s[40:43], s78 offen offset:1024 sc1
    s_waitcnt lgkmcnt(2)
    buffer_store_dwordx4 v[54:57], v36, s[40:43], s78 offen offset:1536 sc1
    s_waitcnt lgkmcnt(0)
    buffer_store_dwordx4 v[58:61], v36, s[40:43], s78 offen offset:2048 sc1
    s_cmp_lt_u32 s48, 2
    s_cselect_b32 s56, s14, s16
    s_cselect_b32 s57, s15, s17
    s_mov_b32 s58, 0xc8000
    s_mov_b32 s59, 0x20000
    s_xor_b32 s50, s48, s46
    s_andn2_b32 s50, 1, s50
    s_lshl1_add_u32 s50, s47, s50
    s_mul_i32 s66, s50, 102400
    s_mul_i32 s50, s46, 320
    s_add_u32 s66, s66, s50
    v_lshrrev_b32 v38, 3, v1
    v_mul_u32_u24 v38, 1280, v38
    v_lshrrev_b32 v39, 4, v1
    v_and_b32 v40, 7, v1
    v_xor_b32 v40, v39, v40
    v_lshl_add_u32 v8, v40, 4, v38
    v_xor_b32 v9, 64, v8
    v_lshrrev_b32 v38, 2, v1
    v_mul_u32_u24 v38, 1280, v38
    v_and_b32 v40, 3, v1
    v_xor_b32 v40, v39, v40
    v_lshl_add_u32 v10, v40, 4, v38
    s_waitcnt vmcnt(0)
    s_mov_b64 exec, 1
    buffer_store_dword v37, off, s[40:43], s79 sc1
    s_mov_b64 exec, -1
    s_setprio 1
    s_mov_b32 s3, 131072
L_gw_44:
    ds_read_b128 v[38:41], v26 offset:48
    s_sub_u32 s3, s3, 1
    s_waitcnt lgkmcnt(0)
    s_cbranch_scc1 L_gwok_45
    v_min3_u32 v38, v38, v39, v40
    v_min_u32 v38, v38, v41
    v_cmp_gt_u32 vcc, 5, v38
    s_nop 1
    s_cmp_lg_u64 vcc, 0
    s_cbranch_scc0 L_gwok_45
    s_sleep 2
    s_branch L_gw_44
L_gwok_45:
    s_movk_i32 s77, 256
    s_bitcmp1_b32 s46, 0
    s_cselect_b32 s77, 0, s77
    s_add_u32 s76, s66, s77
    s_mul_i32 s80, s48, 5120
    s_add_u32 m0, s80, 0
    s_nop 0
    buffer_load_dwordx4 v10, s[56:59], s76 offen lds
    s_add_u32 s76, s76, 20480
    s_add_u32 m0, s80, 1024
    s_nop 0
    buffer_load_dwordx4 v10, s[56:59], s76 offen lds
    s_add_u32 s76, s76, 20480
    s_add_u32 m0, s80, 2048
    s_nop 0
    buffer_load_dwordx4 v10, s[56:59], s76 offen lds
    s_add_u32 s76, s76, 20480
    s_add_u32 m0, s80, 3072
    s_nop 0
    buffer_load_dwordx4 v10, s[56:59], s76 offen lds
    s_add_u32 s76, s76, 20480
    s_add_u32 m0, s80, 4096
    s_nop 0
    buffer_load_dwordx4 v10, s[56:59], s76 offen lds
    s_mov_b32 s3, 131072
L_gw_46:
    ds_read_b128 v[38:41], v26 offset:48
    s_sub_u32 s3, s3, 1
    s_waitcnt lgkmcnt(0)
    s_cbranch_scc1 L_gwok_47
    v_min3_u32 v38, v38, v39, v40
    v_min_u32 v38, v38, v41
    v_cmp_gt_u32 vcc, 8, v38
    s_nop 1
    s_cmp_lg_u64 vcc, 0
    s_cbranch_scc0 L_gwok_47
    s_sleep 2
    s_branch L_gw_46
L_gwok_47:
    s_bitcmp1_b32 s46, 0
    s_cselect_b32 s77, 64, 0
    s_add_u32 s76, s66, s77
    s_mul_i32 s80, s48, 10240
    s_add_u32 s80, s80, 69760
    s_cmp_eq_u32 s48, 3
    s_cselect_b32 s80, 20480, s80
    s_add_u32 m0, s80, 0
    s_nop 0
    buffer_load_dwordx4 v8, s[56:59], s76 offen lds
    s_add_u32 s76, s76, 10240
    s_add_u32 m0, s80, 1024
    s_nop 0
    buffer_load_dwordx4 v9, s[56:59], s76 offen lds
    s_add_u32 s76, s76, 10240
    s_add_u32 m0, s80, 2048
    s_nop 0
    buffer_load_dwordx4 v8, s[56:59], s76 offen lds
    s_add_u32 s76, s76, 10240
    s_add_u32 m0, s80, 3072
    s_nop 0
    buffer_load_dwordx4 v9, s[56:59], s76 offen lds
    s_add_u32 s76, s76, 10240
    s_add_u32 m0, s80, 4096
    s_nop 0
    buffer_load_dwordx4 v8, s[56:59], s76 offen lds
    s_add_u32 s76, s76, 10240
    s_add_u32 m0, s80, 5120
    s_nop 0
    buffer_load_dwordx4 v9, s[56:59], s76 offen lds
    s_add_u32 s76, s76, 10240
    s_add_u32 m0, s80, 6144
    s_nop 0
    buffer_load_dwordx4 v8, s[56:59], s76 offen lds
    s_add_u32 s76, s76, 10240
    s_add_u32 m0, s80, 7168
    s_nop 0
    buffer_load_dwordx4 v9, s[56:59], s76 offen lds
    s_add_u32 s76, s76, 10240
    s_add_u32 m0, s80, 8192
    s_nop 0
    buffer_load_dwordx4 v8, s[56:59], s76 offen lds
    s_add_u32 s76, s76, 10240
    s_add_u32 m0, s80, 9216
    s_nop 0
    buffer_load_dwordx4 v9, s[56:59], s76 offen lds
    s_cmp_eq_u32 s48, 3
    s_cselect_b32 s74, 14, 11
    s_waitcnt vmcnt(0)
    v_mov_b32 v23, 4
    ds_write_b32 v27, v23 offset:32
    s_mov_b32 s3, 131072
L_gw_48:
    ds_read_b128 v[38:41], v26 offset:48
    s_sub_u32 s3, s3, 1
    s_waitcnt lgkmcnt(0)
    s_cbranch_scc1 L_gwok_49
    v_min3_u32 v38, v38, v39, v40
    v_min_u32 v38, v38, v41
    v_cmp_gt_u32 vcc, s74, v38
    s_nop 1
    s_cmp_lg_u64 vcc, 0
    s_cbranch_scc0 L_gwok_49
    s_sleep 2
    s_branch L_gw_48
L_gwok_49:
    s_movk_i32 s77, 128
    s_bitcmp1_b32 s46, 0
    s_cselect_b32 s77, 192, s77
    s_add_u32 s76, s66, s77
    s_mul_i32 s80, s48, 10240
    s_add_u32 s80, s80, 108800
    s_cmp_eq_u32 s48, 3
    s_cselect_b32 s80, 30720, s80
    s_add_u32 m0, s80, 0
    s_nop 0
    buffer_load_dwordx4 v8, s[56:59], s76 offen lds
    s_add_u32 s76, s76, 10240
    s_add_u32 m0, s80, 1024
    s_nop 0
    buffer_load_dwordx4 v9, s[56:59], s76 offen lds
    s_add_u32 s76, s76, 10240
    s_add_u32 m0, s80, 2048
    s_nop 0
    buffer_load_dwordx4 v8, s[56:59], s76 offen lds
    s_add_u32 s76, s76, 10240
    s_add_u32 m0, s80, 3072
    s_nop 0
    buffer_load_dwordx4 v9, s[56:59], s76 offen lds
    s_add_u32 s76, s76, 10240
    s_add_u32 m0, s80, 4096
    s_nop 0
    buffer_load_dwordx4 v8, s[56:59], s76 offen lds
    s_add_u32 s76, s76, 10240
    s_add_u32 m0, s80, 5120
    s_nop 0
    buffer_load_dwordx4 v9, s[56:59], s76 offen lds
    s_add_u32 s76, s76, 10240
    s_add_u32 m0, s80, 6144
    s_nop 0
    buffer_load_dwordx4 v8, s[56:59], s76 offen lds
    s_add_u32 s76, s76, 10240
    s_add_u32 m0, s80, 7168
    s_nop 0
    buffer_load_dwordx4 v9, s[56:59], s76 offen lds
    s_add_u32 s76, s76, 10240
    s_add_u32 m0, s80, 8192
    s_nop 0
    buffer_load_dwordx4 v8, s[56:59], s76 offen lds
    s_add_u32 s76, s76, 10240
    s_add_u32 m0, s80, 9216
    s_nop 0
    buffer_load_dwordx4 v9, s[56:59], s76 offen lds
    s_waitcnt vmcnt(0)
    v_mov_b32 v23, 5
    ds_write_b32 v27, v23 offset:32
    s_waitcnt lgkmcnt(0)
    s_endpgm
L_end:
    s_endpgm
.section .rodata,"a"
.p2align 6
.amdhsa_kernel gated_mix__ssm_conv_s5__dense_activation_squared_relu__prompt_kernel
  .amdhsa_next_free_vgpr 256
  .amdhsa_next_free_sgpr 102
  .amdhsa_accum_offset 256
  .amdhsa_group_segment_fixed_size 0
  .amdhsa_kernarg_size 144
  .amdhsa_user_sgpr_count 2
  .amdhsa_user_sgpr_kernarg_segment_ptr 1
  .amdhsa_system_sgpr_workgroup_id_x 1
  .amdhsa_float_denorm_mode_32 3
.end_amdhsa_kernel
```
